```python
import torch

def _softmax(x, axis=-1):
    return torch.softmax(x, dim=axis)
def _gelu(x):
    return torch.nn.functional.gelu(x, approximate="tanh")
def _silu(x):
    return torch.nn.functional.silu(x)
def _sigmoid(x):
    return torch.sigmoid(x)
def _layernorm(x, axis=-1, eps=1e-5):
    m = x.mean(dim=axis, keepdim=True)
    v = x.var(dim=axis, keepdim=True, unbiased=False)
    return (x - m) / torch.sqrt(v + eps)
def _scatter_add(tgt, idx, src, axis=0):
    return tgt.clone().index_add_(axis, idx, src)
def _segment_sum(src, seg, n):
    out = torch.zeros((n,) + src.shape[1:], dtype=src.dtype)
    return out.index_add_(0, seg, src)
def _pad(x, pw):
    flat = tuple(v for pair in reversed(pw) for v in pair)
    return torch.nn.functional.pad(x, flat)

kernel_name = 'standalone__gqa_softmax__near_ridge'

def setup_inputs():

    _w = (lambda a: (lambda t: t.to(torch.bfloat16) if t.is_floating_point() else t)(torch.as_tensor(a)))
    B, Hq, Hkv, Sq, Sk, D = 8, 32, 32, 256, 2048, 128
    return {
        "q": _w((lambda *s: torch.randn(*s, dtype=torch.bfloat16) * 0.8)(B, Hq, Sq, D)),
        "k": _w((lambda *s: torch.randn(*s, dtype=torch.bfloat16) * 0.8)(B, Hkv, Sk, D)),
        "v": _w((lambda *s: torch.randn(*s, dtype=torch.bfloat16) * 0.05)(B, Hkv, Sk, D)),
    }

def reference(q, k, v):
    B, Hq, Sq, D = q.shape
    Hkv = k.shape[1]
    rep = Hq // Hkv
    k = (lambda x, n, axis: torch.repeat_interleave(x, n, dim=axis))(k, rep, axis=1)
    v = (lambda x, n, axis: torch.repeat_interleave(x, n, dim=axis))(v, rep, axis=1)
    scale = D ** -0.5
    scores = torch.einsum("bhqd,bhkd->bhqk", q, k) * scale
    p = _softmax(scores, axis=-1)
    return torch.einsum("bhqk,bhkd->bhqd", p, v)
```

```asm
; @launch grid=(256,1,1) block=(256,1,1) lds=152128
.amdgcn_target "amdgcn-amd-amdhsa--gfx950"
.text
.globl standalone__gqa_softmax__near_ridge_kernel
.p2align 8
.type standalone__gqa_softmax__near_ridge_kernel,@function
standalone__gqa_softmax__near_ridge_kernel:
    s_cmp_ge_u32 s2, 256
    s_cbranch_scc1 L_end
    s_load_dwordx4 s[4:7], s[0:1], 0
    s_load_dwordx4 s[96:99], s[0:1], 16
    s_getpc_b64 s[94:95]
    v_mul_u32_u24 v8, 72, v0
    global_load_dword v9, v8, s[94:95]
    v_mov_b32 v248, v0
    v_lshrrev_b32 v1, 6, v0
    v_and_b32 v2, 63, v0
    v_readfirstlane_b32 s28, v1
    v_bfe_u32 v3, v2, 2, 2
    v_and_b32 v4, 3, v2
    v_lshrrev_b32 v5, 4, v2
    v_lshlrev_b32 v6, 8, v3
    v_lshl_add_u32 v6, v5, 6, v6
    v_lshl_add_u32 v6, v4, 4, v6
    v_lshl_add_u32 v7, v1, 14, v6
    v_add_u32 v124, 128, v7
    v_add_u32 v125, 96, v7
    v_add_u32 v126, 64, v7
    v_add_u32 v127, 32, v7
    v_lshl_add_u32 v228, v1, 15, v6
    v_add_u32 v231, 21408, v228
    v_add_u32 v230, 14272, v228
    v_add_u32 v229, 7136, v228
    s_mul_i32 s26, s28, 4224
    s_lshl_b32 s29, s2, 19
    s_lshl_b32 s30, s2, 16
    s_bfe_u32 s44, s2, 0x30003
    s_lshl_b32 s44, s44, 10
    s_lshr_b32 s31, s2, 6
    s_lshl_b32 s31, s31, 17
    s_or_b32 s44, s44, s31
    s_mov_b32 s27, 0
    s_getreg_b32 s3, hwreg(HW_REG_XCC_ID)
    s_waitcnt lgkmcnt(0)
    s_add_u32 s16, s4, s30
    s_addc_u32 s17, s5, 0
    s_sub_u32 s16, s16, 128
    s_subb_u32 s17, s17, 0
    s_mov_b32 s18, 65664
    s_mov_b32 s19, 0x20000
    s_add_u32 m0, s26, 84480
    s_mov_b32 s45, 0
    buffer_load_dwordx4 v124, s[16:19], s45 offen offset:0 nt lds
    buffer_load_dwordx4 v125, s[16:19], s45 offen offset:1056 nt lds
    buffer_load_dwordx4 v126, s[16:19], s45 offen offset:2112 nt lds
    buffer_load_dwordx4 v127, s[16:19], s45 offen offset:3168 nt lds
    s_add_u32 s8, s6, s29
    s_addc_u32 s9, s7, 0
    s_mov_b32 s10, 524288
    s_mov_b32 s11, 0x20000
    s_bitcmp1_b32 s3, 0
    s_cbranch_scc1 L_thr1
    s_waitcnt vmcnt(0)
L_thr1:
    s_add_u32 m0, s26, 0
    s_mov_b32 s45, s44
    buffer_load_dwordx4 v228, s[8:11], s45 offen offset:0 nt lds
    buffer_load_dwordx4 v229, s[8:11], s45 offen offset:1056 nt lds
    buffer_load_dwordx4 v230, s[8:11], s45 offen offset:2112 nt lds
    buffer_load_dwordx4 v231, s[8:11], s45 offen offset:3168 nt lds
    s_add_u32 s12, s96, s29
    s_addc_u32 s13, s97, 0
    s_mov_b32 s14, 524288
    s_mov_b32 s15, 0x20000
    s_bitcmp1_b32 s3, 0
    s_cbranch_scc1 L_thr2
    s_waitcnt vmcnt(0)
L_thr2:
    s_add_u32 m0, s26, 16896
    s_mov_b32 s45, s44
    buffer_load_dwordx4 v228, s[12:15], s45 offen offset:0 nt lds
    buffer_load_dwordx4 v229, s[12:15], s45 offen offset:1056 nt lds
    buffer_load_dwordx4 v230, s[12:15], s45 offen offset:2112 nt lds
    buffer_load_dwordx4 v231, s[12:15], s45 offen offset:3168 nt lds
    s_add_u32 s20, s98, s30
    s_addc_u32 s21, s99, 0
    s_mov_b32 s22, 65536
    s_mov_b32 s23, 0x20000
    v_mul_u32_u24 v6, 1056, v3
    v_lshl_add_u32 v6, v4, 6, v6
    v_lshl_add_u32 v226, v5, 4, v6
    v_mul_u32_u24 v6, 1056, v5
    v_lshl_add_u32 v6, v3, 6, v6
    v_lshl_add_u32 v6, v4, 3, v6
    v_add_u32 v227, 16896, v6
    v_cmp_eq_u32 vcc, 0, v4
    v_mov_b32 v6, 0x3f803f80
    v_mov_b32 v224, v226
    v_mov_b32 v225, v227
    v_cndmask_b32 v6, 0, v6, vcc
    v_accvgpr_write_b32 a192, v6
    v_accvgpr_write_b32 a193, v6
    v_accvgpr_write_b32 a194, v6
    v_accvgpr_write_b32 a195, v6
    s_add_u32 s29, s26, 84480
    v_add_u32 v247, s29, v226
    s_mov_b32 s32, 0x3e0293ee
    s_mov_b32 s33, 0x3e0293ee
    s_waitcnt vmcnt(8)
    ds_read_b128 v[96:99], v247 offset:0
    ds_read_b128 v[100:103], v247 offset:256
    ds_read_b128 v[104:107], v247 offset:512
    ds_read_b128 v[108:111], v247 offset:768
    s_add_u32 m0, s26, 101376
    s_mov_b32 s45, 4096
    buffer_load_dwordx4 v124, s[16:19], s45 offen offset:0 nt lds
    buffer_load_dwordx4 v125, s[16:19], s45 offen offset:1056 nt lds
    buffer_load_dwordx4 v126, s[16:19], s45 offen offset:2112 nt lds
    buffer_load_dwordx4 v127, s[16:19], s45 offen offset:3168 nt lds
    s_waitcnt lgkmcnt(3)
    v_lshlrev_b32 v232, 16, v96
    v_and_b32 v233, 0xffff0000, v96
    v_pk_mul_f32 v[232:233], v[232:233], s[32:33]
    v_cvt_pk_bf16_f32 v232, v232, v233
    v_accvgpr_write_b32 a0, v232
    v_lshlrev_b32 v234, 16, v97
    v_and_b32 v235, 0xffff0000, v97
    v_pk_mul_f32 v[234:235], v[234:235], s[32:33]
    v_cvt_pk_bf16_f32 v234, v234, v235
    v_accvgpr_write_b32 a1, v234
    v_lshlrev_b32 v236, 16, v98
    v_and_b32 v237, 0xffff0000, v98
    v_pk_mul_f32 v[236:237], v[236:237], s[32:33]
    v_cvt_pk_bf16_f32 v236, v236, v237
    v_accvgpr_write_b32 a2, v236
    v_lshlrev_b32 v238, 16, v99
    v_and_b32 v239, 0xffff0000, v99
    v_pk_mul_f32 v[238:239], v[238:239], s[32:33]
    v_cvt_pk_bf16_f32 v238, v238, v239
    v_accvgpr_write_b32 a3, v238
    s_waitcnt lgkmcnt(2)
    v_lshlrev_b32 v232, 16, v100
    v_and_b32 v233, 0xffff0000, v100
    v_pk_mul_f32 v[232:233], v[232:233], s[32:33]
    v_cvt_pk_bf16_f32 v232, v232, v233
    v_accvgpr_write_b32 a4, v232
    v_lshlrev_b32 v234, 16, v101
    v_and_b32 v235, 0xffff0000, v101
    v_pk_mul_f32 v[234:235], v[234:235], s[32:33]
    v_cvt_pk_bf16_f32 v234, v234, v235
    v_accvgpr_write_b32 a5, v234
    v_lshlrev_b32 v236, 16, v102
    v_and_b32 v237, 0xffff0000, v102
    v_pk_mul_f32 v[236:237], v[236:237], s[32:33]
    v_cvt_pk_bf16_f32 v236, v236, v237
    v_accvgpr_write_b32 a6, v236
    v_lshlrev_b32 v238, 16, v103
    v_and_b32 v239, 0xffff0000, v103
    v_pk_mul_f32 v[238:239], v[238:239], s[32:33]
    v_cvt_pk_bf16_f32 v238, v238, v239
    v_accvgpr_write_b32 a7, v238
    s_waitcnt lgkmcnt(1)
    v_lshlrev_b32 v232, 16, v104
    v_and_b32 v233, 0xffff0000, v104
    v_pk_mul_f32 v[232:233], v[232:233], s[32:33]
    v_cvt_pk_bf16_f32 v232, v232, v233
    v_accvgpr_write_b32 a8, v232
    v_lshlrev_b32 v234, 16, v105
    v_and_b32 v235, 0xffff0000, v105
    v_pk_mul_f32 v[234:235], v[234:235], s[32:33]
    v_cvt_pk_bf16_f32 v234, v234, v235
    v_accvgpr_write_b32 a9, v234
    v_lshlrev_b32 v236, 16, v106
    v_and_b32 v237, 0xffff0000, v106
    v_pk_mul_f32 v[236:237], v[236:237], s[32:33]
    v_cvt_pk_bf16_f32 v236, v236, v237
    v_accvgpr_write_b32 a10, v236
    v_lshlrev_b32 v238, 16, v107
    v_and_b32 v239, 0xffff0000, v107
    v_pk_mul_f32 v[238:239], v[238:239], s[32:33]
    v_cvt_pk_bf16_f32 v238, v238, v239
    v_accvgpr_write_b32 a11, v238
    s_waitcnt lgkmcnt(0)
    v_lshlrev_b32 v232, 16, v108
    v_and_b32 v233, 0xffff0000, v108
    v_pk_mul_f32 v[232:233], v[232:233], s[32:33]
    v_cvt_pk_bf16_f32 v232, v232, v233
    v_accvgpr_write_b32 a12, v232
    v_lshlrev_b32 v234, 16, v109
    v_and_b32 v235, 0xffff0000, v109
    v_pk_mul_f32 v[234:235], v[234:235], s[32:33]
    v_cvt_pk_bf16_f32 v234, v234, v235
    v_accvgpr_write_b32 a13, v234
    v_lshlrev_b32 v236, 16, v110
    v_and_b32 v237, 0xffff0000, v110
    v_pk_mul_f32 v[236:237], v[236:237], s[32:33]
    v_cvt_pk_bf16_f32 v236, v236, v237
    v_accvgpr_write_b32 a14, v236
    v_lshlrev_b32 v238, 16, v111
    v_and_b32 v239, 0xffff0000, v111
    v_pk_mul_f32 v[238:239], v[238:239], s[32:33]
    v_cvt_pk_bf16_f32 v238, v238, v239
    v_accvgpr_write_b32 a15, v238
    s_waitcnt lgkmcnt(0)
    s_waitcnt vmcnt(8)
    s_add_u32 m0, s26, 118272
    s_mov_b32 s45, 8192
    buffer_load_dwordx4 v124, s[16:19], s45 offen offset:0 nt lds
    buffer_load_dwordx4 v125, s[16:19], s45 offen offset:1056 nt lds
    buffer_load_dwordx4 v126, s[16:19], s45 offen offset:2112 nt lds
    buffer_load_dwordx4 v127, s[16:19], s45 offen offset:3168 nt lds
    s_barrier
    ds_read_b128 a[64:67], v224 offset:0
    ds_read_b128 a[68:71], v224 offset:256
    ds_read_b128 a[72:75], v224 offset:512
    ds_read_b128 a[76:79], v224 offset:768
    ds_read_b128 a[80:83], v224 offset:4224
    ds_read_b128 a[84:87], v224 offset:4480
    ds_read_b128 a[88:91], v224 offset:4736
    ds_read_b128 a[92:95], v224 offset:4992
    ds_read_b128 a[96:99], v224 offset:8448
    ds_read_b128 a[100:103], v224 offset:8704
    ds_read_b128 a[104:107], v224 offset:8960
    ds_read_b128 a[108:111], v224 offset:9216
    ds_read_b128 a[112:115], v224 offset:12672
    ds_read_b128 a[116:119], v224 offset:12928
    ds_read_b128 a[120:123], v224 offset:13184
    ds_read_b128 a[124:127], v224 offset:13440
    s_nop 1
    s_waitcnt lgkmcnt(14)
    v_mfma_f32_16x16x32_bf16 v[144:147], a[64:67], a[0:3], 0
    v_mfma_f32_16x16x32_bf16 v[144:147], a[68:71], a[4:7], v[144:147]
    s_waitcnt lgkmcnt(13)
    v_mfma_f32_16x16x32_bf16 v[144:147], a[72:75], a[8:11], v[144:147]
    s_waitcnt lgkmcnt(12)
    v_mfma_f32_16x16x32_bf16 v[144:147], a[76:79], a[12:15], v[144:147]
    s_waitcnt lgkmcnt(8)
    v_mfma_f32_16x16x32_bf16 v[148:151], a[92:95], a[12:15], 0
    v_mfma_f32_16x16x32_bf16 v[148:151], a[88:91], a[8:11], v[148:151]
    v_mfma_f32_16x16x32_bf16 v[148:151], a[84:87], a[4:7], v[148:151]
    v_mfma_f32_16x16x32_bf16 v[148:151], a[80:83], a[0:3], v[148:151]
    s_waitcnt lgkmcnt(7)
    v_mfma_f32_16x16x32_bf16 v[152:155], a[96:99], a[0:3], 0
    s_waitcnt lgkmcnt(6)
    v_mfma_f32_16x16x32_bf16 v[152:155], a[100:103], a[4:7], v[152:155]
    s_waitcnt lgkmcnt(5)
    v_mfma_f32_16x16x32_bf16 v[152:155], a[104:107], a[8:11], v[152:155]
    s_waitcnt lgkmcnt(4)
    v_mfma_f32_16x16x32_bf16 v[152:155], a[108:111], a[12:15], v[152:155]
    s_waitcnt lgkmcnt(0)
    v_mfma_f32_16x16x32_bf16 v[156:159], a[124:127], a[12:15], 0
    v_mfma_f32_16x16x32_bf16 v[156:159], a[120:123], a[8:11], v[156:159]
    v_mfma_f32_16x16x32_bf16 v[156:159], a[116:119], a[4:7], v[156:159]
    v_mfma_f32_16x16x32_bf16 v[156:159], a[112:115], a[0:3], v[156:159]
    s_nop 2
    v_max3_f32 v240, v144, v145, v146
    v_max3_f32 v240, v240, v147, v148
    v_max3_f32 v240, v240, v149, v150
    v_max3_f32 v240, v240, v151, v152
    v_max3_f32 v240, v240, v153, v154
    v_max3_f32 v240, v240, v155, v156
    v_max3_f32 v240, v240, v157, v158
    v_max_f32 v240, v240, v159
    v_mov_b32 v241, v240
    s_nop 1
    v_permlane16_swap_b32 v240, v241
    s_nop 1
    v_max_f32 v240, v240, v241
    v_mov_b32 v241, v240
    s_nop 1
    v_permlane32_swap_b32 v240, v241
    s_nop 1
    v_max_f32 v240, v240, v241
    v_sub_f32 v144, v144, v240
    v_sub_f32 v145, v145, v240
    v_sub_f32 v146, v146, v240
    v_sub_f32 v147, v147, v240
    v_sub_f32 v148, v148, v240
    v_sub_f32 v149, v149, v240
    v_sub_f32 v150, v150, v240
    v_sub_f32 v151, v151, v240
    v_sub_f32 v152, v152, v240
    v_sub_f32 v153, v153, v240
    v_sub_f32 v154, v154, v240
    v_sub_f32 v155, v155, v240
    v_sub_f32 v156, v156, v240
    v_sub_f32 v157, v157, v240
    v_sub_f32 v158, v158, v240
    v_sub_f32 v159, v159, v240
    v_exp_f32 v144, v144
    v_exp_f32 v145, v145
    v_exp_f32 v146, v146
    v_exp_f32 v147, v147
    v_exp_f32 v148, v148
    v_exp_f32 v149, v149
    v_exp_f32 v150, v150
    v_exp_f32 v151, v151
    v_exp_f32 v152, v152
    v_exp_f32 v153, v153
    v_exp_f32 v154, v154
    v_exp_f32 v155, v155
    v_exp_f32 v156, v156
    v_exp_f32 v157, v157
    v_exp_f32 v158, v158
    v_exp_f32 v159, v159
    v_sub_f32 v208, 0, v240
    v_sub_f32 v209, 0, v240
    v_sub_f32 v210, 0, v240
    v_sub_f32 v211, 0, v240
    v_cvt_pk_bf16_f32 v144, v144, v145
    v_cvt_pk_bf16_f32 v145, v146, v147
    v_cvt_pk_bf16_f32 v146, v148, v149
    v_cvt_pk_bf16_f32 v147, v150, v151
    v_cvt_pk_bf16_f32 v148, v152, v153
    v_cvt_pk_bf16_f32 v149, v154, v155
    v_cvt_pk_bf16_f32 v150, v156, v157
    v_cvt_pk_bf16_f32 v151, v158, v159
    s_waitcnt lgkmcnt(0)
    s_waitcnt vmcnt(8)
    s_add_u32 m0, s26, 135168
    s_mov_b32 s45, 12288
    buffer_load_dwordx4 v124, s[16:19], s45 offen offset:0 nt lds
    buffer_load_dwordx4 v125, s[16:19], s45 offen offset:1056 nt lds
    buffer_load_dwordx4 v126, s[16:19], s45 offen offset:2112 nt lds
    buffer_load_dwordx4 v127, s[16:19], s45 offen offset:3168 nt lds
    s_barrier
    ds_read_b64_tr_b16 a[190:191], v225 offset:13472
    ds_read_b64_tr_b16 a[188:189], v225 offset:9248
    ds_read_b64_tr_b16 a[186:187], v225 offset:5024
    ds_read_b64_tr_b16 a[184:185], v225 offset:800
    ds_read_b64_tr_b16 a[182:183], v225 offset:13440
    ds_read_b64_tr_b16 a[180:181], v225 offset:9216
    ds_read_b64_tr_b16 a[178:179], v225 offset:4992
    ds_read_b64_tr_b16 a[176:177], v225 offset:768
    ds_read_b64_tr_b16 a[174:175], v225 offset:13216
    ds_read_b64_tr_b16 a[172:173], v225 offset:8992
    ds_read_b64_tr_b16 a[170:171], v225 offset:4768
    ds_read_b64_tr_b16 a[168:169], v225 offset:544
    ds_read_b64_tr_b16 a[166:167], v225 offset:13184
    ds_read_b64_tr_b16 a[164:165], v225 offset:8960
    ds_read_b64_tr_b16 a[162:163], v225 offset:4736
    ds_read_b64_tr_b16 a[160:161], v225 offset:512
    ds_read_b64_tr_b16 a[158:159], v225 offset:12960
    ds_read_b64_tr_b16 a[156:157], v225 offset:8736
    ds_read_b64_tr_b16 a[154:155], v225 offset:4512
    ds_read_b64_tr_b16 a[152:153], v225 offset:288
    ds_read_b64_tr_b16 a[150:151], v225 offset:12928
    ds_read_b64_tr_b16 a[148:149], v225 offset:8704
    ds_read_b64_tr_b16 a[146:147], v225 offset:4480
    ds_read_b64_tr_b16 a[144:145], v225 offset:256
    ds_read_b64_tr_b16 a[142:143], v225 offset:12704
    ds_read_b64_tr_b16 a[140:141], v225 offset:8480
    ds_read_b64_tr_b16 a[138:139], v225 offset:4256
    ds_read_b64_tr_b16 a[136:137], v225 offset:32
    ds_read_b64_tr_b16 a[134:135], v225 offset:12672
    ds_read_b64_tr_b16 a[132:133], v225 offset:8448
    ds_read_b64_tr_b16 a[130:131], v225 offset:4224
    ds_read_b64_tr_b16 a[128:129], v225 offset:0
    s_nop 1
    v_mfma_f32_16x16x32_bf16 v[128:131], a[192:195], v[144:147], 0
    v_mfma_f32_16x16x32_bf16 v[128:131], a[192:195], v[148:151], v[128:131]
    s_waitcnt lgkmcnt(14)
    v_mfma_f32_16x16x32_bf16 v[28:31], a[188:191], v[148:151], 0
    v_mfma_f32_16x16x32_bf16 v[28:31], a[184:187], v[144:147], v[28:31]
    v_mfma_f32_16x16x32_bf16 v[24:27], a[176:179], v[144:147], 0
    v_mfma_f32_16x16x32_bf16 v[24:27], a[180:183], v[148:151], v[24:27]
    v_mfma_f32_16x16x32_bf16 v[20:23], a[172:175], v[148:151], 0
    v_mfma_f32_16x16x32_bf16 v[20:23], a[168:171], v[144:147], v[20:23]
    v_mfma_f32_16x16x32_bf16 v[16:19], a[160:163], v[144:147], 0
    v_mfma_f32_16x16x32_bf16 v[16:19], a[164:167], v[148:151], v[16:19]
    v_mfma_f32_16x16x32_bf16 v[12:15], a[156:159], v[148:151], 0
    s_waitcnt lgkmcnt(12)
    v_mfma_f32_16x16x32_bf16 v[12:15], a[152:155], v[144:147], v[12:15]
    s_waitcnt lgkmcnt(8)
    v_mfma_f32_16x16x32_bf16 v[8:11], a[144:147], v[144:147], 0
    v_mfma_f32_16x16x32_bf16 v[8:11], a[148:151], v[148:151], v[8:11]
    s_waitcnt lgkmcnt(6)
    v_mfma_f32_16x16x32_bf16 v[4:7], a[140:143], v[148:151], 0
    s_waitcnt lgkmcnt(4)
    v_mfma_f32_16x16x32_bf16 v[4:7], a[136:139], v[144:147], v[4:7]
    s_waitcnt lgkmcnt(0)
    v_mfma_f32_16x16x32_bf16 v[0:3], a[128:131], v[144:147], 0
    v_mfma_f32_16x16x32_bf16 v[0:3], a[132:135], v[148:151], v[0:3]
    s_waitcnt lgkmcnt(0)
    s_waitcnt vmcnt(8)
    ds_read_b128 v[96:99], v247 offset:16896
    ds_read_b128 v[100:103], v247 offset:17152
    ds_read_b128 v[104:107], v247 offset:17408
    ds_read_b128 v[108:111], v247 offset:17664
    s_add_u32 m0, s26, 33792
    s_or_b32 s44, s44, 0x1e000
    s_add_u32 s44, s44, 0x400
    s_and_b32 s44, s44, 0x61c00
    s_add_u32 s27, s27, 1
    s_mov_b32 s45, s44
    buffer_load_dwordx4 v228, s[8:11], s45 offen offset:0 nt lds
    buffer_load_dwordx4 v229, s[8:11], s45 offen offset:1056 nt lds
    buffer_load_dwordx4 v230, s[8:11], s45 offen offset:2112 nt lds
    buffer_load_dwordx4 v231, s[8:11], s45 offen offset:3168 nt lds
    s_waitcnt lgkmcnt(3)
    v_lshlrev_b32 v232, 16, v96
    v_and_b32 v233, 0xffff0000, v96
    v_pk_mul_f32 v[232:233], v[232:233], s[32:33]
    v_cvt_pk_bf16_f32 v232, v232, v233
    v_accvgpr_write_b32 a16, v232
    v_lshlrev_b32 v234, 16, v97
    v_and_b32 v235, 0xffff0000, v97
    v_pk_mul_f32 v[234:235], v[234:235], s[32:33]
    v_cvt_pk_bf16_f32 v234, v234, v235
    v_accvgpr_write_b32 a17, v234
    v_lshlrev_b32 v236, 16, v98
    v_and_b32 v237, 0xffff0000, v98
    v_pk_mul_f32 v[236:237], v[236:237], s[32:33]
    v_cvt_pk_bf16_f32 v236, v236, v237
    v_accvgpr_write_b32 a18, v236
    v_lshlrev_b32 v238, 16, v99
    v_and_b32 v239, 0xffff0000, v99
    v_pk_mul_f32 v[238:239], v[238:239], s[32:33]
    v_cvt_pk_bf16_f32 v238, v238, v239
    v_accvgpr_write_b32 a19, v238
    s_waitcnt lgkmcnt(2)
    v_lshlrev_b32 v232, 16, v100
    v_and_b32 v233, 0xffff0000, v100
    v_pk_mul_f32 v[232:233], v[232:233], s[32:33]
    v_cvt_pk_bf16_f32 v232, v232, v233
    v_accvgpr_write_b32 a20, v232
    v_lshlrev_b32 v234, 16, v101
    v_and_b32 v235, 0xffff0000, v101
    v_pk_mul_f32 v[234:235], v[234:235], s[32:33]
    v_cvt_pk_bf16_f32 v234, v234, v235
    v_accvgpr_write_b32 a21, v234
    v_lshlrev_b32 v236, 16, v102
    v_and_b32 v237, 0xffff0000, v102
    v_pk_mul_f32 v[236:237], v[236:237], s[32:33]
    v_cvt_pk_bf16_f32 v236, v236, v237
    v_accvgpr_write_b32 a22, v236
    v_lshlrev_b32 v238, 16, v103
    v_and_b32 v239, 0xffff0000, v103
    v_pk_mul_f32 v[238:239], v[238:239], s[32:33]
    v_cvt_pk_bf16_f32 v238, v238, v239
    v_accvgpr_write_b32 a23, v238
    s_waitcnt lgkmcnt(1)
    v_lshlrev_b32 v232, 16, v104
    v_and_b32 v233, 0xffff0000, v104
    v_pk_mul_f32 v[232:233], v[232:233], s[32:33]
    v_cvt_pk_bf16_f32 v232, v232, v233
    v_accvgpr_write_b32 a24, v232
    v_lshlrev_b32 v234, 16, v105
    v_and_b32 v235, 0xffff0000, v105
    v_pk_mul_f32 v[234:235], v[234:235], s[32:33]
    v_cvt_pk_bf16_f32 v234, v234, v235
    v_accvgpr_write_b32 a25, v234
    v_lshlrev_b32 v236, 16, v106
    v_and_b32 v237, 0xffff0000, v106
    v_pk_mul_f32 v[236:237], v[236:237], s[32:33]
    v_cvt_pk_bf16_f32 v236, v236, v237
    v_accvgpr_write_b32 a26, v236
    v_lshlrev_b32 v238, 16, v107
    v_and_b32 v239, 0xffff0000, v107
    v_pk_mul_f32 v[238:239], v[238:239], s[32:33]
    v_cvt_pk_bf16_f32 v238, v238, v239
    v_accvgpr_write_b32 a27, v238
    s_waitcnt lgkmcnt(0)
    v_lshlrev_b32 v232, 16, v108
    v_and_b32 v233, 0xffff0000, v108
    v_pk_mul_f32 v[232:233], v[232:233], s[32:33]
    v_cvt_pk_bf16_f32 v232, v232, v233
    v_accvgpr_write_b32 a28, v232
    v_lshlrev_b32 v234, 16, v109
    v_and_b32 v235, 0xffff0000, v109
    v_pk_mul_f32 v[234:235], v[234:235], s[32:33]
    v_cvt_pk_bf16_f32 v234, v234, v235
    v_accvgpr_write_b32 a29, v234
    v_lshlrev_b32 v236, 16, v110
    v_and_b32 v237, 0xffff0000, v110
    v_pk_mul_f32 v[236:237], v[236:237], s[32:33]
    v_cvt_pk_bf16_f32 v236, v236, v237
    v_accvgpr_write_b32 a30, v236
    v_lshlrev_b32 v238, 16, v111
    v_and_b32 v239, 0xffff0000, v111
    v_pk_mul_f32 v[238:239], v[238:239], s[32:33]
    v_cvt_pk_bf16_f32 v238, v238, v239
    v_accvgpr_write_b32 a31, v238
    s_nop 1
    v_mfma_f32_16x16x32_bf16 v[172:175], a[112:115], a[16:19], 0
    v_mfma_f32_16x16x32_bf16 v[172:175], a[116:119], a[20:23], v[172:175]
    v_mfma_f32_16x16x32_bf16 v[172:175], a[120:123], a[24:27], v[172:175]
    v_mfma_f32_16x16x32_bf16 v[172:175], a[124:127], a[28:31], v[172:175]
    v_mfma_f32_16x16x32_bf16 v[168:171], a[108:111], a[28:31], 0
    v_mfma_f32_16x16x32_bf16 v[168:171], a[104:107], a[24:27], v[168:171]
    v_mfma_f32_16x16x32_bf16 v[168:171], a[100:103], a[20:23], v[168:171]
    v_mfma_f32_16x16x32_bf16 v[168:171], a[96:99], a[16:19], v[168:171]
    v_mfma_f32_16x16x32_bf16 v[164:167], a[80:83], a[16:19], 0
    v_mfma_f32_16x16x32_bf16 v[164:167], a[84:87], a[20:23], v[164:167]
    v_mfma_f32_16x16x32_bf16 v[164:167], a[88:91], a[24:27], v[164:167]
    v_mfma_f32_16x16x32_bf16 v[164:167], a[92:95], a[28:31], v[164:167]
    v_mfma_f32_16x16x32_bf16 v[160:163], a[76:79], a[28:31], 0
    v_mfma_f32_16x16x32_bf16 v[160:163], a[72:75], a[24:27], v[160:163]
    v_mfma_f32_16x16x32_bf16 v[160:163], a[68:71], a[20:23], v[160:163]
    v_mfma_f32_16x16x32_bf16 v[160:163], a[64:67], a[16:19], v[160:163]
    s_nop 2
    v_max3_f32 v240, v175, v174, v173
    v_max3_f32 v240, v240, v172, v171
    v_max3_f32 v240, v240, v170, v169
    v_max3_f32 v240, v240, v168, v167
    v_max3_f32 v240, v240, v166, v165
    v_max3_f32 v240, v240, v164, v163
    v_max3_f32 v240, v240, v162, v161
    v_max_f32 v240, v240, v160
    v_mov_b32 v241, v240
    s_nop 1
    v_permlane16_swap_b32 v240, v241
    s_nop 1
    v_max_f32 v240, v240, v241
    v_mov_b32 v241, v240
    s_nop 1
    v_permlane32_swap_b32 v240, v241
    s_nop 1
    v_max_f32 v240, v240, v241
    v_sub_f32 v175, v175, v240
    v_sub_f32 v174, v174, v240
    v_sub_f32 v173, v173, v240
    v_sub_f32 v172, v172, v240
    v_sub_f32 v171, v171, v240
    v_sub_f32 v170, v170, v240
    v_sub_f32 v169, v169, v240
    v_sub_f32 v168, v168, v240
    v_sub_f32 v167, v167, v240
    v_sub_f32 v166, v166, v240
    v_sub_f32 v165, v165, v240
    v_sub_f32 v164, v164, v240
    v_sub_f32 v163, v163, v240
    v_sub_f32 v162, v162, v240
    v_sub_f32 v161, v161, v240
    v_sub_f32 v160, v160, v240
    v_exp_f32 v175, v175
    v_exp_f32 v174, v174
    v_exp_f32 v173, v173
    v_exp_f32 v172, v172
    v_exp_f32 v171, v171
    v_exp_f32 v170, v170
    v_exp_f32 v169, v169
    v_exp_f32 v168, v168
    v_exp_f32 v167, v167
    v_exp_f32 v166, v166
    v_exp_f32 v165, v165
    v_exp_f32 v164, v164
    v_exp_f32 v163, v163
    v_exp_f32 v162, v162
    v_exp_f32 v161, v161
    v_exp_f32 v160, v160
    v_sub_f32 v212, 0, v240
    v_sub_f32 v213, 0, v240
    v_sub_f32 v214, 0, v240
    v_sub_f32 v215, 0, v240
    v_cvt_pk_bf16_f32 v175, v174, v175
    v_cvt_pk_bf16_f32 v174, v172, v173
    v_cvt_pk_bf16_f32 v173, v170, v171
    v_cvt_pk_bf16_f32 v172, v168, v169
    v_cvt_pk_bf16_f32 v171, v166, v167
    v_cvt_pk_bf16_f32 v170, v164, v165
    v_cvt_pk_bf16_f32 v169, v162, v163
    v_cvt_pk_bf16_f32 v168, v160, v161
    s_waitcnt lgkmcnt(0)
    s_waitcnt vmcnt(8)
    ds_read_b128 v[96:99], v247 offset:33792
    ds_read_b128 v[100:103], v247 offset:34048
    ds_read_b128 v[104:107], v247 offset:34304
    ds_read_b128 v[108:111], v247 offset:34560
    s_add_u32 m0, s26, 50688
    s_mov_b32 s45, s44
    buffer_load_dwordx4 v228, s[12:15], s45 offen offset:0 nt lds
    buffer_load_dwordx4 v229, s[12:15], s45 offen offset:1056 nt lds
    buffer_load_dwordx4 v230, s[12:15], s45 offen offset:2112 nt lds
    buffer_load_dwordx4 v231, s[12:15], s45 offen offset:3168 nt lds
    s_waitcnt lgkmcnt(3)
    v_lshlrev_b32 v232, 16, v96
    v_and_b32 v233, 0xffff0000, v96
    v_pk_mul_f32 v[232:233], v[232:233], s[32:33]
    v_cvt_pk_bf16_f32 v232, v232, v233
    v_accvgpr_write_b32 a32, v232
    v_lshlrev_b32 v234, 16, v97
    v_and_b32 v235, 0xffff0000, v97
    v_pk_mul_f32 v[234:235], v[234:235], s[32:33]
    v_cvt_pk_bf16_f32 v234, v234, v235
    v_accvgpr_write_b32 a33, v234
    v_lshlrev_b32 v236, 16, v98
    v_and_b32 v237, 0xffff0000, v98
    v_pk_mul_f32 v[236:237], v[236:237], s[32:33]
    v_cvt_pk_bf16_f32 v236, v236, v237
    v_accvgpr_write_b32 a34, v236
    v_lshlrev_b32 v238, 16, v99
    v_and_b32 v239, 0xffff0000, v99
    v_pk_mul_f32 v[238:239], v[238:239], s[32:33]
    v_cvt_pk_bf16_f32 v238, v238, v239
    v_accvgpr_write_b32 a35, v238
    s_waitcnt lgkmcnt(2)
    v_lshlrev_b32 v232, 16, v100
    v_and_b32 v233, 0xffff0000, v100
    v_pk_mul_f32 v[232:233], v[232:233], s[32:33]
    v_cvt_pk_bf16_f32 v232, v232, v233
    v_accvgpr_write_b32 a36, v232
    v_lshlrev_b32 v234, 16, v101
    v_and_b32 v235, 0xffff0000, v101
    v_pk_mul_f32 v[234:235], v[234:235], s[32:33]
    v_cvt_pk_bf16_f32 v234, v234, v235
    v_accvgpr_write_b32 a37, v234
    v_lshlrev_b32 v236, 16, v102
    v_and_b32 v237, 0xffff0000, v102
    v_pk_mul_f32 v[236:237], v[236:237], s[32:33]
    v_cvt_pk_bf16_f32 v236, v236, v237
    v_accvgpr_write_b32 a38, v236
    v_lshlrev_b32 v238, 16, v103
    v_and_b32 v239, 0xffff0000, v103
    v_pk_mul_f32 v[238:239], v[238:239], s[32:33]
    v_cvt_pk_bf16_f32 v238, v238, v239
    v_accvgpr_write_b32 a39, v238
    s_waitcnt lgkmcnt(1)
    v_lshlrev_b32 v232, 16, v104
    v_and_b32 v233, 0xffff0000, v104
    v_pk_mul_f32 v[232:233], v[232:233], s[32:33]
    v_cvt_pk_bf16_f32 v232, v232, v233
    v_accvgpr_write_b32 a40, v232
    v_lshlrev_b32 v234, 16, v105
    v_and_b32 v235, 0xffff0000, v105
    v_pk_mul_f32 v[234:235], v[234:235], s[32:33]
    v_cvt_pk_bf16_f32 v234, v234, v235
    v_accvgpr_write_b32 a41, v234
    v_lshlrev_b32 v236, 16, v106
    v_and_b32 v237, 0xffff0000, v106
    v_pk_mul_f32 v[236:237], v[236:237], s[32:33]
    v_cvt_pk_bf16_f32 v236, v236, v237
    v_accvgpr_write_b32 a42, v236
    v_lshlrev_b32 v238, 16, v107
    v_and_b32 v239, 0xffff0000, v107
    v_pk_mul_f32 v[238:239], v[238:239], s[32:33]
    v_cvt_pk_bf16_f32 v238, v238, v239
    v_accvgpr_write_b32 a43, v238
    s_waitcnt lgkmcnt(0)
    v_lshlrev_b32 v232, 16, v108
    v_and_b32 v233, 0xffff0000, v108
    v_pk_mul_f32 v[232:233], v[232:233], s[32:33]
    v_cvt_pk_bf16_f32 v232, v232, v233
    v_accvgpr_write_b32 a44, v232
    v_lshlrev_b32 v234, 16, v109
    v_and_b32 v235, 0xffff0000, v109
    v_pk_mul_f32 v[234:235], v[234:235], s[32:33]
    v_cvt_pk_bf16_f32 v234, v234, v235
    v_accvgpr_write_b32 a45, v234
    v_lshlrev_b32 v236, 16, v110
    v_and_b32 v237, 0xffff0000, v110
    v_pk_mul_f32 v[236:237], v[236:237], s[32:33]
    v_cvt_pk_bf16_f32 v236, v236, v237
    v_accvgpr_write_b32 a46, v236
    v_lshlrev_b32 v238, 16, v111
    v_and_b32 v239, 0xffff0000, v111
    v_pk_mul_f32 v[238:239], v[238:239], s[32:33]
    v_cvt_pk_bf16_f32 v238, v238, v239
    v_accvgpr_write_b32 a47, v238
    s_nop 1
    v_mfma_f32_16x16x32_bf16 v[176:179], a[64:67], a[32:35], 0
    v_mfma_f32_16x16x32_bf16 v[176:179], a[68:71], a[36:39], v[176:179]
    v_mfma_f32_16x16x32_bf16 v[176:179], a[72:75], a[40:43], v[176:179]
    v_mfma_f32_16x16x32_bf16 v[176:179], a[76:79], a[44:47], v[176:179]
    v_mfma_f32_16x16x32_bf16 v[180:183], a[92:95], a[44:47], 0
    v_mfma_f32_16x16x32_bf16 v[180:183], a[88:91], a[40:43], v[180:183]
    v_mfma_f32_16x16x32_bf16 v[180:183], a[84:87], a[36:39], v[180:183]
    v_mfma_f32_16x16x32_bf16 v[180:183], a[80:83], a[32:35], v[180:183]
    v_mfma_f32_16x16x32_bf16 v[184:187], a[96:99], a[32:35], 0
    v_mfma_f32_16x16x32_bf16 v[184:187], a[100:103], a[36:39], v[184:187]
    v_mfma_f32_16x16x32_bf16 v[184:187], a[104:107], a[40:43], v[184:187]
    v_mfma_f32_16x16x32_bf16 v[184:187], a[108:111], a[44:47], v[184:187]
    v_mfma_f32_16x16x32_bf16 v[188:191], a[124:127], a[44:47], 0
    v_mfma_f32_16x16x32_bf16 v[188:191], a[120:123], a[40:43], v[188:191]
    v_mfma_f32_16x16x32_bf16 v[188:191], a[116:119], a[36:39], v[188:191]
    v_mfma_f32_16x16x32_bf16 v[188:191], a[112:115], a[32:35], v[188:191]
    v_mfma_f32_16x16x32_bf16 v[32:35], a[132:135], v[172:175], 0
    v_mfma_f32_16x16x32_bf16 v[32:35], a[128:131], v[168:171], v[32:35]
    v_mfma_f32_16x16x32_bf16 v[36:39], a[136:139], v[168:171], 0
    v_max3_f32 v240, v176, v177, v178
    v_max3_f32 v240, v240, v179, v180
    v_max3_f32 v240, v240, v181, v182
    v_max3_f32 v240, v240, v183, v184
    v_max3_f32 v240, v240, v185, v186
    v_mfma_f32_16x16x32_bf16 v[36:39], a[140:143], v[172:175], v[36:39]
    v_max3_f32 v240, v240, v187, v188
    v_max3_f32 v240, v240, v189, v190
    v_max_f32 v240, v240, v191
    v_mov_b32 v241, v240
    v_mfma_f32_16x16x32_bf16 v[40:43], a[148:151], v[172:175], 0
    s_nop 1
    v_permlane16_swap_b32 v240, v241
    s_nop 1
    v_mfma_f32_16x16x32_bf16 v[40:43], a[144:147], v[168:171], v[40:43]
    v_max_f32 v240, v240, v241
    v_mov_b32 v241, v240
    s_nop 1
    v_permlane32_swap_b32 v240, v241
    v_mfma_f32_16x16x32_bf16 v[44:47], a[152:155], v[168:171], 0
    s_nop 1
    v_max_f32 v240, v240, v241
    v_sub_f32 v176, v176, v240
    v_sub_f32 v177, v177, v240
    v_mfma_f32_16x16x32_bf16 v[44:47], a[156:159], v[172:175], v[44:47]
    v_sub_f32 v178, v178, v240
    v_sub_f32 v179, v179, v240
    v_sub_f32 v180, v180, v240
    v_sub_f32 v181, v181, v240
    v_sub_f32 v182, v182, v240
    v_mfma_f32_16x16x32_bf16 v[48:51], a[164:167], v[172:175], 0
    v_sub_f32 v183, v183, v240
    v_sub_f32 v184, v184, v240
    v_sub_f32 v185, v185, v240
    v_sub_f32 v186, v186, v240
    v_sub_f32 v187, v187, v240
    v_mfma_f32_16x16x32_bf16 v[48:51], a[160:163], v[168:171], v[48:51]
    v_sub_f32 v188, v188, v240
    v_sub_f32 v189, v189, v240
    v_sub_f32 v190, v190, v240
    v_sub_f32 v191, v191, v240
    v_mfma_f32_16x16x32_bf16 v[52:55], a[168:171], v[168:171], 0
    v_exp_f32 v176, v176
    v_exp_f32 v177, v177
    v_mfma_f32_16x16x32_bf16 v[52:55], a[172:175], v[172:175], v[52:55]
    v_exp_f32 v178, v178
    v_exp_f32 v179, v179
    v_mfma_f32_16x16x32_bf16 v[56:59], a[180:183], v[172:175], 0
    v_exp_f32 v180, v180
    v_exp_f32 v181, v181
    v_mfma_f32_16x16x32_bf16 v[56:59], a[176:179], v[168:171], v[56:59]
    v_exp_f32 v182, v182
    v_exp_f32 v183, v183
    v_mfma_f32_16x16x32_bf16 v[60:63], a[184:187], v[168:171], 0
    v_exp_f32 v184, v184
    v_exp_f32 v185, v185
    v_mfma_f32_16x16x32_bf16 v[60:63], a[188:191], v[172:175], v[60:63]
    v_exp_f32 v186, v186
    v_exp_f32 v187, v187
    v_mfma_f32_16x16x32_bf16 v[132:135], a[192:195], v[172:175], 0
    v_exp_f32 v188, v188
    v_exp_f32 v189, v189
    v_mfma_f32_16x16x32_bf16 v[132:135], a[192:195], v[168:171], v[132:135]
    v_exp_f32 v190, v190
    v_exp_f32 v191, v191
    v_sub_f32 v216, 0, v240
    v_sub_f32 v217, 0, v240
    v_sub_f32 v218, 0, v240
    v_sub_f32 v219, 0, v240
    v_cvt_pk_bf16_f32 v176, v176, v177
    v_cvt_pk_bf16_f32 v177, v178, v179
    v_cvt_pk_bf16_f32 v178, v180, v181
    v_cvt_pk_bf16_f32 v179, v182, v183
    v_cvt_pk_bf16_f32 v180, v184, v185
    v_cvt_pk_bf16_f32 v181, v186, v187
    v_cvt_pk_bf16_f32 v182, v188, v189
    v_cvt_pk_bf16_f32 v183, v190, v191
    s_waitcnt lgkmcnt(0)
    s_waitcnt vmcnt(8)
    ds_read_b128 v[96:99], v247 offset:50688
    ds_read_b128 v[100:103], v247 offset:50944
    ds_read_b128 v[104:107], v247 offset:51200
    ds_read_b128 v[108:111], v247 offset:51456
    s_add_u32 m0, s26, 67584
    s_or_b32 s44, s44, 0x1e000
    s_add_u32 s44, s44, 0x400
    s_and_b32 s44, s44, 0x61c00
    s_add_u32 s27, s27, 1
    s_mov_b32 s45, s44
    buffer_load_dwordx4 v228, s[8:11], s45 offen offset:0 nt lds
    buffer_load_dwordx4 v229, s[8:11], s45 offen offset:1056 nt lds
    buffer_load_dwordx4 v230, s[8:11], s45 offen offset:2112 nt lds
    buffer_load_dwordx4 v231, s[8:11], s45 offen offset:3168 nt lds
    s_waitcnt lgkmcnt(3)
    v_lshlrev_b32 v232, 16, v96
    v_and_b32 v233, 0xffff0000, v96
    v_pk_mul_f32 v[232:233], v[232:233], s[32:33]
    v_cvt_pk_bf16_f32 v232, v232, v233
    v_accvgpr_write_b32 a48, v232
    v_lshlrev_b32 v234, 16, v97
    v_and_b32 v235, 0xffff0000, v97
    v_pk_mul_f32 v[234:235], v[234:235], s[32:33]
    v_cvt_pk_bf16_f32 v234, v234, v235
    v_accvgpr_write_b32 a49, v234
    v_lshlrev_b32 v236, 16, v98
    v_and_b32 v237, 0xffff0000, v98
    v_pk_mul_f32 v[236:237], v[236:237], s[32:33]
    v_cvt_pk_bf16_f32 v236, v236, v237
    v_accvgpr_write_b32 a50, v236
    v_lshlrev_b32 v238, 16, v99
    v_and_b32 v239, 0xffff0000, v99
    v_pk_mul_f32 v[238:239], v[238:239], s[32:33]
    v_cvt_pk_bf16_f32 v238, v238, v239
    v_accvgpr_write_b32 a51, v238
    s_waitcnt lgkmcnt(2)
    v_lshlrev_b32 v232, 16, v100
    v_and_b32 v233, 0xffff0000, v100
    v_pk_mul_f32 v[232:233], v[232:233], s[32:33]
    v_cvt_pk_bf16_f32 v232, v232, v233
    v_accvgpr_write_b32 a52, v232
    v_lshlrev_b32 v234, 16, v101
    v_and_b32 v235, 0xffff0000, v101
    v_pk_mul_f32 v[234:235], v[234:235], s[32:33]
    v_cvt_pk_bf16_f32 v234, v234, v235
    v_accvgpr_write_b32 a53, v234
    v_lshlrev_b32 v236, 16, v102
    v_and_b32 v237, 0xffff0000, v102
    v_pk_mul_f32 v[236:237], v[236:237], s[32:33]
    v_cvt_pk_bf16_f32 v236, v236, v237
    v_accvgpr_write_b32 a54, v236
    v_lshlrev_b32 v238, 16, v103
    v_and_b32 v239, 0xffff0000, v103
    v_pk_mul_f32 v[238:239], v[238:239], s[32:33]
    v_cvt_pk_bf16_f32 v238, v238, v239
    v_accvgpr_write_b32 a55, v238
    s_waitcnt lgkmcnt(1)
    v_lshlrev_b32 v232, 16, v104
    v_and_b32 v233, 0xffff0000, v104
    v_pk_mul_f32 v[232:233], v[232:233], s[32:33]
    v_cvt_pk_bf16_f32 v232, v232, v233
    v_accvgpr_write_b32 a56, v232
    v_lshlrev_b32 v234, 16, v105
    v_and_b32 v235, 0xffff0000, v105
    v_pk_mul_f32 v[234:235], v[234:235], s[32:33]
    v_cvt_pk_bf16_f32 v234, v234, v235
    v_accvgpr_write_b32 a57, v234
    v_lshlrev_b32 v236, 16, v106
    v_and_b32 v237, 0xffff0000, v106
    v_pk_mul_f32 v[236:237], v[236:237], s[32:33]
    v_cvt_pk_bf16_f32 v236, v236, v237
    v_accvgpr_write_b32 a58, v236
    v_lshlrev_b32 v238, 16, v107
    v_and_b32 v239, 0xffff0000, v107
    v_pk_mul_f32 v[238:239], v[238:239], s[32:33]
    v_cvt_pk_bf16_f32 v238, v238, v239
    v_accvgpr_write_b32 a59, v238
    s_waitcnt lgkmcnt(0)
    v_lshlrev_b32 v232, 16, v108
    v_and_b32 v233, 0xffff0000, v108
    v_pk_mul_f32 v[232:233], v[232:233], s[32:33]
    v_cvt_pk_bf16_f32 v232, v232, v233
    v_accvgpr_write_b32 a60, v232
    v_lshlrev_b32 v234, 16, v109
    v_and_b32 v235, 0xffff0000, v109
    v_pk_mul_f32 v[234:235], v[234:235], s[32:33]
    v_cvt_pk_bf16_f32 v234, v234, v235
    v_accvgpr_write_b32 a61, v234
    v_lshlrev_b32 v236, 16, v110
    v_and_b32 v237, 0xffff0000, v110
    v_pk_mul_f32 v[236:237], v[236:237], s[32:33]
    v_cvt_pk_bf16_f32 v236, v236, v237
    v_accvgpr_write_b32 a62, v236
    v_lshlrev_b32 v238, 16, v111
    v_and_b32 v239, 0xffff0000, v111
    v_pk_mul_f32 v[238:239], v[238:239], s[32:33]
    v_cvt_pk_bf16_f32 v238, v238, v239
    v_accvgpr_write_b32 a63, v238
    s_nop 1
    v_mfma_f32_16x16x32_bf16 v[204:207], a[112:115], a[48:51], 0
    v_mfma_f32_16x16x32_bf16 v[204:207], a[116:119], a[52:55], v[204:207]
    v_mfma_f32_16x16x32_bf16 v[204:207], a[120:123], a[56:59], v[204:207]
    v_mfma_f32_16x16x32_bf16 v[204:207], a[124:127], a[60:63], v[204:207]
    v_mfma_f32_16x16x32_bf16 v[200:203], a[108:111], a[60:63], 0
    v_mfma_f32_16x16x32_bf16 v[200:203], a[104:107], a[56:59], v[200:203]
    v_mfma_f32_16x16x32_bf16 v[200:203], a[100:103], a[52:55], v[200:203]
    v_mfma_f32_16x16x32_bf16 v[200:203], a[96:99], a[48:51], v[200:203]
    v_mfma_f32_16x16x32_bf16 v[196:199], a[80:83], a[48:51], 0
    v_mfma_f32_16x16x32_bf16 v[196:199], a[84:87], a[52:55], v[196:199]
    v_mfma_f32_16x16x32_bf16 v[196:199], a[88:91], a[56:59], v[196:199]
    v_mfma_f32_16x16x32_bf16 v[196:199], a[92:95], a[60:63], v[196:199]
    v_mfma_f32_16x16x32_bf16 v[192:195], a[76:79], a[60:63], 0
    v_mfma_f32_16x16x32_bf16 v[192:195], a[72:75], a[56:59], v[192:195]
    v_mfma_f32_16x16x32_bf16 v[192:195], a[68:71], a[52:55], v[192:195]
    v_mfma_f32_16x16x32_bf16 v[192:195], a[64:67], a[48:51], v[192:195]
    v_mfma_f32_16x16x32_bf16 v[136:139], a[192:195], v[176:179], 0
    v_mfma_f32_16x16x32_bf16 v[136:139], a[192:195], v[180:183], v[136:139]
    v_mfma_f32_16x16x32_bf16 v[92:95], a[188:191], v[180:183], 0
    v_max3_f32 v240, v207, v206, v205
    v_max3_f32 v240, v240, v204, v203
    v_max3_f32 v240, v240, v202, v201
    v_max3_f32 v240, v240, v200, v199
    v_max3_f32 v240, v240, v198, v197
    v_mfma_f32_16x16x32_bf16 v[92:95], a[184:187], v[176:179], v[92:95]
    v_max3_f32 v240, v240, v196, v195
    v_max3_f32 v240, v240, v194, v193
    v_max_f32 v240, v240, v192
    v_mov_b32 v241, v240
    v_mfma_f32_16x16x32_bf16 v[88:91], a[176:179], v[176:179], 0
    s_nop 1
    v_permlane16_swap_b32 v240, v241
    s_nop 1
    v_mfma_f32_16x16x32_bf16 v[88:91], a[180:183], v[180:183], v[88:91]
    v_max_f32 v240, v240, v241
    v_mov_b32 v241, v240
    s_nop 1
    v_permlane32_swap_b32 v240, v241
    v_mfma_f32_16x16x32_bf16 v[84:87], a[172:175], v[180:183], 0
    s_nop 1
    v_max_f32 v240, v240, v241
    v_sub_f32 v207, v207, v240
    v_sub_f32 v206, v206, v240
    v_mfma_f32_16x16x32_bf16 v[84:87], a[168:171], v[176:179], v[84:87]
    v_sub_f32 v205, v205, v240
    v_sub_f32 v204, v204, v240
    v_sub_f32 v203, v203, v240
    v_sub_f32 v202, v202, v240
    v_sub_f32 v201, v201, v240
    v_mfma_f32_16x16x32_bf16 v[80:83], a[160:163], v[176:179], 0
    v_sub_f32 v200, v200, v240
    v_sub_f32 v199, v199, v240
    v_sub_f32 v198, v198, v240
    v_sub_f32 v197, v197, v240
    v_sub_f32 v196, v196, v240
    v_mfma_f32_16x16x32_bf16 v[80:83], a[164:167], v[180:183], v[80:83]
    v_sub_f32 v195, v195, v240
    v_sub_f32 v194, v194, v240
    v_sub_f32 v193, v193, v240
    v_sub_f32 v192, v192, v240
    v_mfma_f32_16x16x32_bf16 v[76:79], a[156:159], v[180:183], 0
    v_exp_f32 v207, v207
    v_exp_f32 v206, v206
    v_mfma_f32_16x16x32_bf16 v[76:79], a[152:155], v[176:179], v[76:79]
    v_exp_f32 v205, v205
    v_exp_f32 v204, v204
    v_mfma_f32_16x16x32_bf16 v[72:75], a[144:147], v[176:179], 0
    v_exp_f32 v203, v203
    v_exp_f32 v202, v202
    v_mfma_f32_16x16x32_bf16 v[72:75], a[148:151], v[180:183], v[72:75]
    v_exp_f32 v201, v201
    v_exp_f32 v200, v200
    v_mfma_f32_16x16x32_bf16 v[68:71], a[140:143], v[180:183], 0
    v_exp_f32 v199, v199
    v_exp_f32 v198, v198
    v_mfma_f32_16x16x32_bf16 v[68:71], a[136:139], v[176:179], v[68:71]
    v_exp_f32 v197, v197
    v_exp_f32 v196, v196
    v_mfma_f32_16x16x32_bf16 v[64:67], a[128:131], v[176:179], 0
    v_exp_f32 v195, v195
    v_exp_f32 v194, v194
    v_mfma_f32_16x16x32_bf16 v[64:67], a[132:135], v[180:183], v[64:67]
    v_exp_f32 v193, v193
    v_exp_f32 v192, v192
    v_sub_f32 v220, 0, v240
    v_sub_f32 v221, 0, v240
    v_sub_f32 v222, 0, v240
    v_sub_f32 v223, 0, v240
    v_cvt_pk_bf16_f32 v207, v206, v207
    v_cvt_pk_bf16_f32 v206, v204, v205
    v_cvt_pk_bf16_f32 v205, v202, v203
    v_cvt_pk_bf16_f32 v204, v200, v201
    v_cvt_pk_bf16_f32 v203, v198, v199
    v_cvt_pk_bf16_f32 v202, v196, v197
    v_cvt_pk_bf16_f32 v201, v194, v195
    v_cvt_pk_bf16_f32 v200, v192, v193
    s_waitcnt lgkmcnt(0)
    s_waitcnt vmcnt(8)
    s_barrier
    v_add_u32 v224, 33792, v226
    v_add_u32 v225, 33792, v227
    v_mfma_f32_16x16x32_bf16 v[96:99], a[132:135], v[204:207], 0
    ds_read_b128 a[64:67], v224 offset:0
    v_mfma_f32_16x16x32_bf16 v[96:99], a[128:131], v[200:203], v[96:99]
    ds_read_b128 a[68:71], v224 offset:256
    v_mfma_f32_16x16x32_bf16 v[100:103], a[136:139], v[200:203], 0
    ds_read_b128 a[72:75], v224 offset:512
    v_mfma_f32_16x16x32_bf16 v[100:103], a[140:143], v[204:207], v[100:103]
    ds_read_b128 a[76:79], v224 offset:768
    v_mfma_f32_16x16x32_bf16 v[104:107], a[148:151], v[204:207], 0
    ds_read_b128 a[80:83], v224 offset:4224
    v_mfma_f32_16x16x32_bf16 v[104:107], a[144:147], v[200:203], v[104:107]
    ds_read_b128 a[84:87], v224 offset:4480
    v_mfma_f32_16x16x32_bf16 v[108:111], a[152:155], v[200:203], 0
    ds_read_b128 a[88:91], v224 offset:4736
    v_mfma_f32_16x16x32_bf16 v[108:111], a[156:159], v[204:207], v[108:111]
    ds_read_b128 a[92:95], v224 offset:4992
    v_mfma_f32_16x16x32_bf16 v[112:115], a[164:167], v[204:207], 0
    ds_read_b128 a[96:99], v224 offset:8448
    v_mfma_f32_16x16x32_bf16 v[112:115], a[160:163], v[200:203], v[112:115]
    ds_read_b128 a[100:103], v224 offset:8704
    v_mfma_f32_16x16x32_bf16 v[116:119], a[168:171], v[200:203], 0
    ds_read_b128 a[104:107], v224 offset:8960
    v_mfma_f32_16x16x32_bf16 v[116:119], a[172:175], v[204:207], v[116:119]
    ds_read_b128 a[108:111], v224 offset:9216
    v_mfma_f32_16x16x32_bf16 v[120:123], a[180:183], v[204:207], 0
    ds_read_b128 a[112:115], v224 offset:12672
    v_mfma_f32_16x16x32_bf16 v[120:123], a[176:179], v[200:203], v[120:123]
    ds_read_b128 a[116:119], v224 offset:12928
    v_mfma_f32_16x16x32_bf16 v[124:127], a[184:187], v[200:203], 0
    ds_read_b128 a[120:123], v224 offset:13184
    v_mfma_f32_16x16x32_bf16 v[124:127], a[188:191], v[204:207], v[124:127]
    ds_read_b128 a[124:127], v224 offset:13440
    v_mfma_f32_16x16x32_bf16 v[140:143], a[192:195], v[204:207], 0
    v_mfma_f32_16x16x32_bf16 v[140:143], a[192:195], v[200:203], v[140:143]
    s_add_u32 m0, s26, 84480
    s_mov_b32 s45, s44
    buffer_load_dwordx4 v228, s[12:15], s45 offen offset:0 nt lds
    buffer_load_dwordx4 v229, s[12:15], s45 offen offset:1056 nt lds
    buffer_load_dwordx4 v230, s[12:15], s45 offen offset:2112 nt lds
    buffer_load_dwordx4 v231, s[12:15], s45 offen offset:3168 nt lds
    s_mov_b32 s24, 0
    s_mov_b32 s35, 33792
    s_mov_b32 s25, 67584
    s_getreg_b32 s3, hwreg(HW_REG_XCC_ID)
    s_bitcmp1_b32 s3, 0
    s_mov_b32 s29, 0x5443
    s_cselect_b32 s3, 0x3232, s29
    s_lshr_b32 s29, s2, 1
    s_and_b32 s29, s29, 12
    s_lshr_b32 s3, s3, s29
    s_and_b32 s3, s3, 15
    s_cmp_lt_u32 s27, s3
    s_cbranch_scc0 L_handover
L_fill:
    s_waitcnt lgkmcnt(0)
    v_mfma_f32_16x16x32_bf16 v[144:147], a[64:67], a[0:3], v[208:211]
    s_add_u32 s30, s25, 33792
    s_cmp_eq_u32 s30, 135168
    s_cselect_b32 s30, 0, s30
    s_add_u32 m0, s30, s26
    s_or_b32 s44, s44, 0x1e000
    s_add_u32 s44, s44, 0x400
    s_and_b32 s44, s44, 0x61c00
    s_add_u32 s27, s27, 1
    s_cmp_lt_u32 s27, 32
    s_cselect_b32 s45, s44, 0x100000
    v_mfma_f32_16x16x32_bf16 v[144:147], a[68:71], a[4:7], v[144:147]
    v_mfma_f32_16x16x32_bf16 v[144:147], a[72:75], a[8:11], v[144:147]
    v_mfma_f32_16x16x32_bf16 v[144:147], a[76:79], a[12:15], v[144:147]
    v_mfma_f32_16x16x32_bf16 v[148:151], a[92:95], a[12:15], v[208:211]
    v_mfma_f32_16x16x32_bf16 v[148:151], a[88:91], a[8:11], v[148:151]
    v_mfma_f32_16x16x32_bf16 v[148:151], a[84:87], a[4:7], v[148:151]
    v_mfma_f32_16x16x32_bf16 v[148:151], a[80:83], a[0:3], v[148:151]
    v_mfma_f32_16x16x32_bf16 v[152:155], a[96:99], a[0:3], v[208:211]
    v_mfma_f32_16x16x32_bf16 v[152:155], a[100:103], a[4:7], v[152:155]
    v_mfma_f32_16x16x32_bf16 v[152:155], a[104:107], a[8:11], v[152:155]
    v_mfma_f32_16x16x32_bf16 v[152:155], a[108:111], a[12:15], v[152:155]
    v_mfma_f32_16x16x32_bf16 v[156:159], a[124:127], a[12:15], v[208:211]
    v_mfma_f32_16x16x32_bf16 v[156:159], a[120:123], a[8:11], v[156:159]
    v_mfma_f32_16x16x32_bf16 v[156:159], a[116:119], a[4:7], v[156:159]
    v_mfma_f32_16x16x32_bf16 v[156:159], a[112:115], a[0:3], v[156:159]
    v_mfma_f32_16x16x32_bf16 v[172:175], a[112:115], a[16:19], v[212:215]
    v_mfma_f32_16x16x32_bf16 v[172:175], a[116:119], a[20:23], v[172:175]
    v_mfma_f32_16x16x32_bf16 v[172:175], a[120:123], a[24:27], v[172:175]
    v_mfma_f32_16x16x32_bf16 v[172:175], a[124:127], a[28:31], v[172:175]
    v_mfma_f32_16x16x32_bf16 v[168:171], a[108:111], a[28:31], v[212:215]
    v_mfma_f32_16x16x32_bf16 v[168:171], a[104:107], a[24:27], v[168:171]
    v_mfma_f32_16x16x32_bf16 v[168:171], a[100:103], a[20:23], v[168:171]
    v_mfma_f32_16x16x32_bf16 v[168:171], a[96:99], a[16:19], v[168:171]
    v_mfma_f32_16x16x32_bf16 v[164:167], a[80:83], a[16:19], v[212:215]
    v_mfma_f32_16x16x32_bf16 v[164:167], a[84:87], a[20:23], v[164:167]
    v_mfma_f32_16x16x32_bf16 v[164:167], a[88:91], a[24:27], v[164:167]
    v_mfma_f32_16x16x32_bf16 v[164:167], a[92:95], a[28:31], v[164:167]
    v_mfma_f32_16x16x32_bf16 v[160:163], a[76:79], a[28:31], v[212:215]
    v_mfma_f32_16x16x32_bf16 v[160:163], a[72:75], a[24:27], v[160:163]
    v_mfma_f32_16x16x32_bf16 v[160:163], a[68:71], a[20:23], v[160:163]
    v_mfma_f32_16x16x32_bf16 v[160:163], a[64:67], a[16:19], v[160:163]
    s_waitcnt vmcnt(8)
    s_barrier
    v_mfma_f32_16x16x32_bf16 v[176:179], a[64:67], a[32:35], v[216:219]
    ds_read_b64_tr_b16 a[128:129], v225 offset:0
    v_mfma_f32_16x16x32_bf16 v[176:179], a[68:71], a[36:39], v[176:179]
    ds_read_b64_tr_b16 a[130:131], v225 offset:4224
    v_mfma_f32_16x16x32_bf16 v[176:179], a[72:75], a[40:43], v[176:179]
    ds_read_b64_tr_b16 a[132:133], v225 offset:8448
    v_mfma_f32_16x16x32_bf16 v[176:179], a[76:79], a[44:47], v[176:179]
    ds_read_b64_tr_b16 a[134:135], v225 offset:12672
    v_mfma_f32_16x16x32_bf16 v[180:183], a[92:95], a[44:47], v[216:219]
    ds_read_b64_tr_b16 a[136:137], v225 offset:32
    v_mfma_f32_16x16x32_bf16 v[180:183], a[88:91], a[40:43], v[180:183]
    ds_read_b64_tr_b16 a[138:139], v225 offset:4256
    v_mfma_f32_16x16x32_bf16 v[180:183], a[84:87], a[36:39], v[180:183]
    ds_read_b64_tr_b16 a[140:141], v225 offset:8480
    v_mfma_f32_16x16x32_bf16 v[180:183], a[80:83], a[32:35], v[180:183]
    ds_read_b64_tr_b16 a[142:143], v225 offset:12704
    v_mfma_f32_16x16x32_bf16 v[184:187], a[96:99], a[32:35], v[216:219]
    ds_read_b64_tr_b16 a[144:145], v225 offset:256
    v_mfma_f32_16x16x32_bf16 v[184:187], a[100:103], a[36:39], v[184:187]
    ds_read_b64_tr_b16 a[146:147], v225 offset:4480
    v_mfma_f32_16x16x32_bf16 v[184:187], a[104:107], a[40:43], v[184:187]
    ds_read_b64_tr_b16 a[148:149], v225 offset:8704
    v_mfma_f32_16x16x32_bf16 v[184:187], a[108:111], a[44:47], v[184:187]
    ds_read_b64_tr_b16 a[150:151], v225 offset:12928
    v_mfma_f32_16x16x32_bf16 v[188:191], a[124:127], a[44:47], v[216:219]
    ds_read_b64_tr_b16 a[152:153], v225 offset:288
    v_mfma_f32_16x16x32_bf16 v[188:191], a[120:123], a[40:43], v[188:191]
    ds_read_b64_tr_b16 a[154:155], v225 offset:4512
    v_mfma_f32_16x16x32_bf16 v[188:191], a[116:119], a[36:39], v[188:191]
    ds_read_b64_tr_b16 a[156:157], v225 offset:8736
    v_mfma_f32_16x16x32_bf16 v[188:191], a[112:115], a[32:35], v[188:191]
    ds_read_b64_tr_b16 a[158:159], v225 offset:12960
    v_mfma_f32_16x16x32_bf16 v[204:207], a[112:115], a[48:51], v[220:223]
    ds_read_b64_tr_b16 a[160:161], v225 offset:512
    v_mfma_f32_16x16x32_bf16 v[204:207], a[116:119], a[52:55], v[204:207]
    ds_read_b64_tr_b16 a[162:163], v225 offset:4736
    v_mfma_f32_16x16x32_bf16 v[204:207], a[120:123], a[56:59], v[204:207]
    ds_read_b64_tr_b16 a[164:165], v225 offset:8960
    v_mfma_f32_16x16x32_bf16 v[204:207], a[124:127], a[60:63], v[204:207]
    ds_read_b64_tr_b16 a[166:167], v225 offset:13184
    v_mfma_f32_16x16x32_bf16 v[200:203], a[108:111], a[60:63], v[220:223]
    ds_read_b64_tr_b16 a[168:169], v225 offset:544
    v_mfma_f32_16x16x32_bf16 v[200:203], a[104:107], a[56:59], v[200:203]
    ds_read_b64_tr_b16 a[170:171], v225 offset:4768
    v_mfma_f32_16x16x32_bf16 v[200:203], a[100:103], a[52:55], v[200:203]
    ds_read_b64_tr_b16 a[172:173], v225 offset:8992
    v_mfma_f32_16x16x32_bf16 v[200:203], a[96:99], a[48:51], v[200:203]
    ds_read_b64_tr_b16 a[174:175], v225 offset:13216
    v_mfma_f32_16x16x32_bf16 v[196:199], a[80:83], a[48:51], v[220:223]
    ds_read_b64_tr_b16 a[176:177], v225 offset:768
    v_mfma_f32_16x16x32_bf16 v[196:199], a[84:87], a[52:55], v[196:199]
    ds_read_b64_tr_b16 a[178:179], v225 offset:4992
    v_mfma_f32_16x16x32_bf16 v[196:199], a[88:91], a[56:59], v[196:199]
    ds_read_b64_tr_b16 a[180:181], v225 offset:9216
    v_mfma_f32_16x16x32_bf16 v[196:199], a[92:95], a[60:63], v[196:199]
    ds_read_b64_tr_b16 a[182:183], v225 offset:13440
    v_mfma_f32_16x16x32_bf16 v[192:195], a[76:79], a[60:63], v[220:223]
    ds_read_b64_tr_b16 a[184:185], v225 offset:800
    v_mfma_f32_16x16x32_bf16 v[192:195], a[72:75], a[56:59], v[192:195]
    ds_read_b64_tr_b16 a[186:187], v225 offset:5024
    v_mfma_f32_16x16x32_bf16 v[192:195], a[68:71], a[52:55], v[192:195]
    ds_read_b64_tr_b16 a[188:189], v225 offset:9248
    v_mfma_f32_16x16x32_bf16 v[192:195], a[64:67], a[48:51], v[192:195]
    ds_read_b64_tr_b16 a[190:191], v225 offset:13472
    buffer_load_dwordx4 v228, s[8:11], s45 offen offset:0 nt lds
    buffer_load_dwordx4 v229, s[8:11], s45 offen offset:1056 nt lds
    buffer_load_dwordx4 v230, s[8:11], s45 offen offset:2112 nt lds
    buffer_load_dwordx4 v231, s[8:11], s45 offen offset:3168 nt lds
    s_add_u32 m0, m0, 16896
    v_exp_f32 v144, v144
    v_exp_f32 v145, v145
    v_exp_f32 v146, v146
    v_exp_f32 v147, v147
    v_exp_f32 v148, v148
    v_exp_f32 v149, v149
    v_exp_f32 v150, v150
    v_exp_f32 v151, v151
    v_exp_f32 v152, v152
    v_exp_f32 v153, v153
    v_exp_f32 v154, v154
    v_exp_f32 v155, v155
    v_exp_f32 v156, v156
    v_exp_f32 v157, v157
    v_exp_f32 v158, v158
    v_exp_f32 v159, v159
    v_exp_f32 v175, v175
    v_exp_f32 v174, v174
    v_exp_f32 v173, v173
    v_exp_f32 v172, v172
    v_exp_f32 v171, v171
    v_exp_f32 v170, v170
    v_exp_f32 v169, v169
    v_exp_f32 v168, v168
    v_exp_f32 v167, v167
    v_exp_f32 v166, v166
    v_exp_f32 v165, v165
    v_exp_f32 v164, v164
    v_exp_f32 v163, v163
    v_exp_f32 v162, v162
    v_exp_f32 v161, v161
    v_exp_f32 v160, v160
    v_cvt_pk_bf16_f32 v144, v144, v145
    v_cvt_pk_bf16_f32 v145, v146, v147
    v_cvt_pk_bf16_f32 v146, v148, v149
    v_cvt_pk_bf16_f32 v147, v150, v151
    v_cvt_pk_bf16_f32 v148, v152, v153
    v_cvt_pk_bf16_f32 v149, v154, v155
    v_cvt_pk_bf16_f32 v150, v156, v157
    v_cvt_pk_bf16_f32 v151, v158, v159
    v_exp_f32 v176, v176
    v_exp_f32 v177, v177
    v_exp_f32 v178, v178
    v_exp_f32 v179, v179
    v_exp_f32 v180, v180
    v_exp_f32 v181, v181
    v_exp_f32 v182, v182
    v_exp_f32 v183, v183
    v_exp_f32 v184, v184
    v_exp_f32 v185, v185
    v_exp_f32 v186, v186
    v_exp_f32 v187, v187
    v_exp_f32 v188, v188
    v_exp_f32 v189, v189
    v_exp_f32 v190, v190
    v_exp_f32 v191, v191
    v_cvt_pk_bf16_f32 v175, v174, v175
    v_cvt_pk_bf16_f32 v174, v172, v173
    v_cvt_pk_bf16_f32 v173, v170, v171
    v_cvt_pk_bf16_f32 v172, v168, v169
    v_cvt_pk_bf16_f32 v171, v166, v167
    v_cvt_pk_bf16_f32 v170, v164, v165
    v_cvt_pk_bf16_f32 v169, v162, v163
    v_cvt_pk_bf16_f32 v168, v160, v161
    v_exp_f32 v207, v207
    v_exp_f32 v206, v206
    v_exp_f32 v205, v205
    v_exp_f32 v204, v204
    v_exp_f32 v203, v203
    v_exp_f32 v202, v202
    v_exp_f32 v201, v201
    v_exp_f32 v200, v200
    v_exp_f32 v199, v199
    v_exp_f32 v198, v198
    v_exp_f32 v197, v197
    v_exp_f32 v196, v196
    v_exp_f32 v195, v195
    v_exp_f32 v194, v194
    v_exp_f32 v193, v193
    v_exp_f32 v192, v192
    v_cvt_pk_bf16_f32 v176, v176, v177
    v_cvt_pk_bf16_f32 v177, v178, v179
    v_cvt_pk_bf16_f32 v178, v180, v181
    v_cvt_pk_bf16_f32 v179, v182, v183
    v_cvt_pk_bf16_f32 v180, v184, v185
    v_cvt_pk_bf16_f32 v181, v186, v187
    v_cvt_pk_bf16_f32 v182, v188, v189
    v_cvt_pk_bf16_f32 v183, v190, v191
    v_cvt_pk_bf16_f32 v207, v206, v207
    v_cvt_pk_bf16_f32 v206, v204, v205
    v_cvt_pk_bf16_f32 v205, v202, v203
    v_cvt_pk_bf16_f32 v204, v200, v201
    v_cvt_pk_bf16_f32 v203, v198, v199
    v_cvt_pk_bf16_f32 v202, v196, v197
    v_cvt_pk_bf16_f32 v201, v194, v195
    v_cvt_pk_bf16_f32 v200, v192, v193
    s_waitcnt lgkmcnt(0)
    v_mfma_f32_16x16x32_bf16 v[128:131], a[192:195], v[144:147], v[128:131]
    v_mfma_f32_16x16x32_bf16 v[128:131], a[192:195], v[148:151], v[128:131]
    buffer_load_dwordx4 v228, s[12:15], s45 offen offset:0 nt lds
    v_mfma_f32_16x16x32_bf16 v[28:31], a[188:191], v[148:151], v[28:31]
    v_mfma_f32_16x16x32_bf16 v[28:31], a[184:187], v[144:147], v[28:31]
    v_mfma_f32_16x16x32_bf16 v[24:27], a[176:179], v[144:147], v[24:27]
    v_mfma_f32_16x16x32_bf16 v[24:27], a[180:183], v[148:151], v[24:27]
    v_mfma_f32_16x16x32_bf16 v[20:23], a[172:175], v[148:151], v[20:23]
    v_mfma_f32_16x16x32_bf16 v[20:23], a[168:171], v[144:147], v[20:23]
    buffer_load_dwordx4 v229, s[12:15], s45 offen offset:1056 nt lds
    v_mfma_f32_16x16x32_bf16 v[16:19], a[160:163], v[144:147], v[16:19]
    v_mfma_f32_16x16x32_bf16 v[16:19], a[164:167], v[148:151], v[16:19]
    v_mfma_f32_16x16x32_bf16 v[12:15], a[156:159], v[148:151], v[12:15]
    v_mfma_f32_16x16x32_bf16 v[12:15], a[152:155], v[144:147], v[12:15]
    v_mfma_f32_16x16x32_bf16 v[8:11], a[144:147], v[144:147], v[8:11]
    v_mfma_f32_16x16x32_bf16 v[8:11], a[148:151], v[148:151], v[8:11]
    buffer_load_dwordx4 v230, s[12:15], s45 offen offset:2112 nt lds
    v_mfma_f32_16x16x32_bf16 v[4:7], a[140:143], v[148:151], v[4:7]
    v_mfma_f32_16x16x32_bf16 v[4:7], a[136:139], v[144:147], v[4:7]
    v_mfma_f32_16x16x32_bf16 v[0:3], a[128:131], v[144:147], v[0:3]
    v_mfma_f32_16x16x32_bf16 v[0:3], a[132:135], v[148:151], v[0:3]
    v_mfma_f32_16x16x32_bf16 v[32:35], a[132:135], v[172:175], v[32:35]
    v_mfma_f32_16x16x32_bf16 v[32:35], a[128:131], v[168:171], v[32:35]
    buffer_load_dwordx4 v231, s[12:15], s45 offen offset:3168 nt lds
    v_mfma_f32_16x16x32_bf16 v[36:39], a[136:139], v[168:171], v[36:39]
    v_mfma_f32_16x16x32_bf16 v[36:39], a[140:143], v[172:175], v[36:39]
    v_mfma_f32_16x16x32_bf16 v[40:43], a[148:151], v[172:175], v[40:43]
    v_mfma_f32_16x16x32_bf16 v[40:43], a[144:147], v[168:171], v[40:43]
    v_mfma_f32_16x16x32_bf16 v[44:47], a[152:155], v[168:171], v[44:47]
    v_mfma_f32_16x16x32_bf16 v[44:47], a[156:159], v[172:175], v[44:47]
    v_mfma_f32_16x16x32_bf16 v[48:51], a[164:167], v[172:175], v[48:51]
    v_mfma_f32_16x16x32_bf16 v[48:51], a[160:163], v[168:171], v[48:51]
    v_mfma_f32_16x16x32_bf16 v[52:55], a[168:171], v[168:171], v[52:55]
    v_mfma_f32_16x16x32_bf16 v[52:55], a[172:175], v[172:175], v[52:55]
    v_mfma_f32_16x16x32_bf16 v[56:59], a[180:183], v[172:175], v[56:59]
    v_mfma_f32_16x16x32_bf16 v[56:59], a[176:179], v[168:171], v[56:59]
    v_mfma_f32_16x16x32_bf16 v[60:63], a[184:187], v[168:171], v[60:63]
    v_mfma_f32_16x16x32_bf16 v[60:63], a[188:191], v[172:175], v[60:63]
    v_mfma_f32_16x16x32_bf16 v[132:135], a[192:195], v[172:175], v[132:135]
    v_mfma_f32_16x16x32_bf16 v[132:135], a[192:195], v[168:171], v[132:135]
    s_waitcnt vmcnt(12)
    s_barrier
    v_add_u32 v224, s25, v226
    v_add_u32 v225, s25, v227
    v_mfma_f32_16x16x32_bf16 v[136:139], a[192:195], v[176:179], v[136:139]
    ds_read_b128 a[64:67], v224 offset:0
    v_mfma_f32_16x16x32_bf16 v[136:139], a[192:195], v[180:183], v[136:139]
    v_mfma_f32_16x16x32_bf16 v[92:95], a[188:191], v[180:183], v[92:95]
    ds_read_b128 a[68:71], v224 offset:256
    v_mfma_f32_16x16x32_bf16 v[92:95], a[184:187], v[176:179], v[92:95]
    v_mfma_f32_16x16x32_bf16 v[88:91], a[176:179], v[176:179], v[88:91]
    ds_read_b128 a[72:75], v224 offset:512
    v_mfma_f32_16x16x32_bf16 v[88:91], a[180:183], v[180:183], v[88:91]
    v_mfma_f32_16x16x32_bf16 v[84:87], a[172:175], v[180:183], v[84:87]
    ds_read_b128 a[76:79], v224 offset:768
    v_mfma_f32_16x16x32_bf16 v[84:87], a[168:171], v[176:179], v[84:87]
    v_mfma_f32_16x16x32_bf16 v[80:83], a[160:163], v[176:179], v[80:83]
    ds_read_b128 a[80:83], v224 offset:4224
    v_mfma_f32_16x16x32_bf16 v[80:83], a[164:167], v[180:183], v[80:83]
    v_mfma_f32_16x16x32_bf16 v[76:79], a[156:159], v[180:183], v[76:79]
    ds_read_b128 a[84:87], v224 offset:4480
    v_mfma_f32_16x16x32_bf16 v[76:79], a[152:155], v[176:179], v[76:79]
    v_mfma_f32_16x16x32_bf16 v[72:75], a[144:147], v[176:179], v[72:75]
    ds_read_b128 a[88:91], v224 offset:4736
    v_mfma_f32_16x16x32_bf16 v[72:75], a[148:151], v[180:183], v[72:75]
    v_mfma_f32_16x16x32_bf16 v[68:71], a[140:143], v[180:183], v[68:71]
    ds_read_b128 a[92:95], v224 offset:4992
    v_mfma_f32_16x16x32_bf16 v[68:71], a[136:139], v[176:179], v[68:71]
    v_mfma_f32_16x16x32_bf16 v[64:67], a[128:131], v[176:179], v[64:67]
    ds_read_b128 a[96:99], v224 offset:8448
    v_mfma_f32_16x16x32_bf16 v[64:67], a[132:135], v[180:183], v[64:67]
    v_mfma_f32_16x16x32_bf16 v[96:99], a[132:135], v[204:207], v[96:99]
    ds_read_b128 a[100:103], v224 offset:8704
    v_mfma_f32_16x16x32_bf16 v[96:99], a[128:131], v[200:203], v[96:99]
    v_mfma_f32_16x16x32_bf16 v[100:103], a[136:139], v[200:203], v[100:103]
    ds_read_b128 a[104:107], v224 offset:8960
    v_mfma_f32_16x16x32_bf16 v[100:103], a[140:143], v[204:207], v[100:103]
    v_mfma_f32_16x16x32_bf16 v[104:107], a[148:151], v[204:207], v[104:107]
    ds_read_b128 a[108:111], v224 offset:9216
    v_mfma_f32_16x16x32_bf16 v[104:107], a[144:147], v[200:203], v[104:107]
    v_mfma_f32_16x16x32_bf16 v[108:111], a[152:155], v[200:203], v[108:111]
    ds_read_b128 a[112:115], v224 offset:12672
    v_mfma_f32_16x16x32_bf16 v[108:111], a[156:159], v[204:207], v[108:111]
    v_mfma_f32_16x16x32_bf16 v[112:115], a[164:167], v[204:207], v[112:115]
    ds_read_b128 a[116:119], v224 offset:12928
    v_mfma_f32_16x16x32_bf16 v[112:115], a[160:163], v[200:203], v[112:115]
    v_mfma_f32_16x16x32_bf16 v[116:119], a[168:171], v[200:203], v[116:119]
    ds_read_b128 a[120:123], v224 offset:13184
    v_mfma_f32_16x16x32_bf16 v[116:119], a[172:175], v[204:207], v[116:119]
    v_mfma_f32_16x16x32_bf16 v[120:123], a[180:183], v[204:207], v[120:123]
    ds_read_b128 a[124:127], v224 offset:13440
    s_mov_b32 s24, s35
    s_mov_b32 s35, s25
    s_mov_b32 s25, s30
    s_cmp_lt_u32 s27, s3
    v_mfma_f32_16x16x32_bf16 v[120:123], a[176:179], v[200:203], v[120:123]
    v_mfma_f32_16x16x32_bf16 v[124:127], a[184:187], v[200:203], v[124:127]
    v_mfma_f32_16x16x32_bf16 v[124:127], a[188:191], v[204:207], v[124:127]
    v_mfma_f32_16x16x32_bf16 v[140:143], a[192:195], v[204:207], v[140:143]
    v_mfma_f32_16x16x32_bf16 v[140:143], a[192:195], v[200:203], v[140:143]
    s_cbranch_scc1 L_fill
L_handover:
    s_waitcnt vmcnt(8)
    s_barrier
    ds_read_b64_tr_b16 a[128:129], v225 offset:0
    ds_read_b64_tr_b16 a[130:131], v225 offset:4224
    ds_read_b64_tr_b16 a[132:133], v225 offset:8448
    ds_read_b64_tr_b16 a[134:135], v225 offset:12672
    ds_read_b64_tr_b16 a[136:137], v225 offset:32
    ds_read_b64_tr_b16 a[138:139], v225 offset:4256
    ds_read_b64_tr_b16 a[140:141], v225 offset:8480
    ds_read_b64_tr_b16 a[142:143], v225 offset:12704
    s_add_u32 s30, s25, 33792
    s_cmp_eq_u32 s30, 135168
    s_cselect_b32 s30, 0, s30
    s_add_u32 m0, s30, s26
    s_or_b32 s44, s44, 0x1e000
    s_add_u32 s44, s44, 0x400
    s_and_b32 s44, s44, 0x61c00
    s_add_u32 s27, s27, 1
    s_cmp_lt_u32 s27, 32
    s_cselect_b32 s45, s44, 0x100000
    ds_read_b64_tr_b16 a[144:145], v225 offset:256
    ds_read_b64_tr_b16 a[146:147], v225 offset:4480
    ds_read_b64_tr_b16 a[148:149], v225 offset:8704
    ds_read_b64_tr_b16 a[150:151], v225 offset:12928
    ds_read_b64_tr_b16 a[152:153], v225 offset:288
    ds_read_b64_tr_b16 a[154:155], v225 offset:4512
    ds_read_b64_tr_b16 a[156:157], v225 offset:8736
    buffer_load_dwordx4 v228, s[8:11], s45 offen offset:0 nt lds
    buffer_load_dwordx4 v229, s[8:11], s45 offen offset:1056 nt lds
    buffer_load_dwordx4 v230, s[8:11], s45 offen offset:2112 nt lds
    buffer_load_dwordx4 v231, s[8:11], s45 offen offset:3168 nt lds
    s_and_b32 s29, s28, 1
    s_cmp_eq_u32 s29, 1
    s_cbranch_scc1 L_loop1
.p2align 6
L_loop0:
    s_waitcnt lgkmcnt(14)
    v_mfma_f32_16x16x32_bf16 v[144:147], a[64:67], a[0:3], v[208:211]
    ds_read_b64_tr_b16 a[158:159], v225 offset:12960
    s_add_u32 m0, m0, 16896
    v_mfma_f32_16x16x32_bf16 v[144:147], a[68:71], a[4:7], v[144:147]
    ds_read_b64_tr_b16 a[160:161], v225 offset:512
    v_mfma_f32_16x16x32_bf16 v[144:147], a[72:75], a[8:11], v[144:147]
    ds_read_b64_tr_b16 a[162:163], v225 offset:4736
    v_mfma_f32_16x16x32_bf16 v[144:147], a[76:79], a[12:15], v[144:147]
    ds_read_b64_tr_b16 a[164:165], v225 offset:8960
    s_or_b32 s44, s44, 0x1e000
    v_mfma_f32_16x16x32_bf16 v[148:151], a[92:95], a[12:15], v[208:211]
    ds_read_b64_tr_b16 a[166:167], v225 offset:13184
    s_add_u32 s44, s44, 0x400
    v_mfma_f32_16x16x32_bf16 v[148:151], a[88:91], a[8:11], v[148:151]
    ds_read_b64_tr_b16 a[168:169], v225 offset:544
    s_and_b32 s44, s44, 0x61c00
    v_mfma_f32_16x16x32_bf16 v[148:151], a[84:87], a[4:7], v[148:151]
    ds_read_b64_tr_b16 a[170:171], v225 offset:4768
    s_add_u32 s27, s27, 1
    v_mfma_f32_16x16x32_bf16 v[148:151], a[80:83], a[0:3], v[148:151]
    ds_read_b64_tr_b16 a[172:173], v225 offset:8992
    v_mfma_f32_16x16x32_bf16 v[152:155], a[96:99], a[0:3], v[208:211]
    v_exp_f32 v144, v144
    v_mfma_f32_16x16x32_bf16 v[152:155], a[100:103], a[4:7], v[152:155]
    v_exp_f32 v145, v145
    v_mfma_f32_16x16x32_bf16 v[152:155], a[104:107], a[8:11], v[152:155]
    v_exp_f32 v146, v146
    v_mfma_f32_16x16x32_bf16 v[152:155], a[108:111], a[12:15], v[152:155]
    buffer_load_dwordx4 v228, s[12:15], s45 offen offset:0 nt lds
    v_mfma_f32_16x16x32_bf16 v[156:159], a[124:127], a[12:15], v[208:211]
    v_exp_f32 v147, v147
    v_mfma_f32_16x16x32_bf16 v[156:159], a[120:123], a[8:11], v[156:159]
    v_exp_f32 v148, v148
    v_mfma_f32_16x16x32_bf16 v[156:159], a[116:119], a[4:7], v[156:159]
    v_cvt_pk_bf16_f32 v144, v144, v145
    v_cvt_pk_bf16_f32 v145, v146, v147
    v_mfma_f32_16x16x32_bf16 v[156:159], a[112:115], a[0:3], v[156:159]
    ds_read_b64_tr_b16 a[174:175], v225 offset:13216
    v_mfma_f32_16x16x32_bf16 v[172:175], a[112:115], a[16:19], v[212:215]
    v_exp_f32 v149, v149
    v_mfma_f32_16x16x32_bf16 v[172:175], a[116:119], a[20:23], v[172:175]
    v_exp_f32 v150, v150
    v_mfma_f32_16x16x32_bf16 v[172:175], a[120:123], a[24:27], v[172:175]
    v_exp_f32 v151, v151
    v_mfma_f32_16x16x32_bf16 v[172:175], a[124:127], a[28:31], v[172:175]
    buffer_load_dwordx4 v229, s[12:15], s45 offen offset:1056 nt lds
    v_mfma_f32_16x16x32_bf16 v[168:171], a[108:111], a[28:31], v[212:215]
    v_exp_f32 v152, v152
    v_mfma_f32_16x16x32_bf16 v[168:171], a[104:107], a[24:27], v[168:171]
    v_cvt_pk_bf16_f32 v146, v148, v149
    v_cvt_pk_bf16_f32 v147, v150, v151
    v_mfma_f32_16x16x32_bf16 v[168:171], a[100:103], a[20:23], v[168:171]
    v_exp_f32 v153, v153
    v_mfma_f32_16x16x32_bf16 v[168:171], a[96:99], a[16:19], v[168:171]
    ds_read_b64_tr_b16 a[176:177], v225 offset:768
    v_cvt_pk_bf16_f32 v148, v152, v153
    v_mfma_f32_16x16x32_bf16 v[164:167], a[80:83], a[16:19], v[212:215]
    v_exp_f32 v154, v154
    v_mfma_f32_16x16x32_bf16 v[164:167], a[84:87], a[20:23], v[164:167]
    v_exp_f32 v155, v155
    v_mfma_f32_16x16x32_bf16 v[164:167], a[88:91], a[24:27], v[164:167]
    v_exp_f32 v156, v156
    v_mfma_f32_16x16x32_bf16 v[164:167], a[92:95], a[28:31], v[164:167]
    buffer_load_dwordx4 v230, s[12:15], s45 offen offset:2112 nt lds
    v_mfma_f32_16x16x32_bf16 v[160:163], a[76:79], a[28:31], v[212:215]
    v_exp_f32 v157, v157
    v_mfma_f32_16x16x32_bf16 v[160:163], a[72:75], a[24:27], v[160:163]
    v_exp_f32 v158, v158
    v_mfma_f32_16x16x32_bf16 v[160:163], a[68:71], a[20:23], v[160:163]
    v_cvt_pk_bf16_f32 v149, v154, v155
    v_cvt_pk_bf16_f32 v150, v156, v157
    v_mfma_f32_16x16x32_bf16 v[160:163], a[64:67], a[16:19], v[160:163]
    ds_read_b64_tr_b16 a[178:179], v225 offset:4992
    v_mfma_f32_16x16x32_bf16 v[176:179], a[64:67], a[32:35], v[216:219]
    v_exp_f32 v159, v159
    v_mfma_f32_16x16x32_bf16 v[176:179], a[68:71], a[36:39], v[176:179]
    v_exp_f32 v175, v175
    v_mfma_f32_16x16x32_bf16 v[176:179], a[72:75], a[40:43], v[176:179]
    v_exp_f32 v174, v174
    v_mfma_f32_16x16x32_bf16 v[176:179], a[76:79], a[44:47], v[176:179]
    buffer_load_dwordx4 v231, s[12:15], s45 offen offset:3168 nt lds
    v_mfma_f32_16x16x32_bf16 v[180:183], a[92:95], a[44:47], v[216:219]
    v_exp_f32 v173, v173
    v_mfma_f32_16x16x32_bf16 v[180:183], a[88:91], a[40:43], v[180:183]
    v_cvt_pk_bf16_f32 v151, v158, v159
    v_cvt_pk_bf16_f32 v175, v174, v175
    v_mfma_f32_16x16x32_bf16 v[180:183], a[84:87], a[36:39], v[180:183]
    v_exp_f32 v172, v172
    v_mfma_f32_16x16x32_bf16 v[180:183], a[80:83], a[32:35], v[180:183]
    ds_read_b64_tr_b16 a[180:181], v225 offset:9216
    v_cvt_pk_bf16_f32 v174, v172, v173
    v_mfma_f32_16x16x32_bf16 v[184:187], a[96:99], a[32:35], v[216:219]
    v_exp_f32 v171, v171
    v_mfma_f32_16x16x32_bf16 v[184:187], a[100:103], a[36:39], v[184:187]
    v_exp_f32 v170, v170
    v_mfma_f32_16x16x32_bf16 v[184:187], a[104:107], a[40:43], v[184:187]
    v_exp_f32 v169, v169
    v_mfma_f32_16x16x32_bf16 v[184:187], a[108:111], a[44:47], v[184:187]
    ds_read_b64_tr_b16 a[182:183], v225 offset:13440
    v_cvt_pk_bf16_f32 v173, v170, v171
    v_mfma_f32_16x16x32_bf16 v[188:191], a[124:127], a[44:47], v[216:219]
    v_exp_f32 v168, v168
    v_mfma_f32_16x16x32_bf16 v[188:191], a[120:123], a[40:43], v[188:191]
    v_exp_f32 v167, v167
    v_mfma_f32_16x16x32_bf16 v[188:191], a[116:119], a[36:39], v[188:191]
    v_exp_f32 v166, v166
    v_mfma_f32_16x16x32_bf16 v[188:191], a[112:115], a[32:35], v[188:191]
    ds_read_b64_tr_b16 a[184:185], v225 offset:800
    v_cvt_pk_bf16_f32 v172, v168, v169
    v_mfma_f32_16x16x32_bf16 v[204:207], a[112:115], a[48:51], v[220:223]
    v_exp_f32 v165, v165
    v_mfma_f32_16x16x32_bf16 v[204:207], a[116:119], a[52:55], v[204:207]
    v_exp_f32 v164, v164
    v_mfma_f32_16x16x32_bf16 v[204:207], a[120:123], a[56:59], v[204:207]
    v_exp_f32 v163, v163
    v_mfma_f32_16x16x32_bf16 v[204:207], a[124:127], a[60:63], v[204:207]
    ds_read_b64_tr_b16 a[186:187], v225 offset:5024
    v_cvt_pk_bf16_f32 v171, v166, v167
    v_mfma_f32_16x16x32_bf16 v[200:203], a[108:111], a[60:63], v[220:223]
    v_exp_f32 v162, v162
    v_mfma_f32_16x16x32_bf16 v[200:203], a[104:107], a[56:59], v[200:203]
    v_exp_f32 v161, v161
    v_mfma_f32_16x16x32_bf16 v[200:203], a[100:103], a[52:55], v[200:203]
    v_cvt_pk_bf16_f32 v170, v164, v165
    v_cvt_pk_bf16_f32 v169, v162, v163
    v_mfma_f32_16x16x32_bf16 v[200:203], a[96:99], a[48:51], v[200:203]
    ds_read_b64_tr_b16 a[188:189], v225 offset:9248
    v_mfma_f32_16x16x32_bf16 v[196:199], a[80:83], a[48:51], v[220:223]
    v_exp_f32 v160, v160
    v_mfma_f32_16x16x32_bf16 v[196:199], a[84:87], a[52:55], v[196:199]
    v_exp_f32 v176, v176
    v_mfma_f32_16x16x32_bf16 v[196:199], a[88:91], a[56:59], v[196:199]
    v_exp_f32 v177, v177
    v_mfma_f32_16x16x32_bf16 v[196:199], a[92:95], a[60:63], v[196:199]
    ds_read_b64_tr_b16 a[190:191], v225 offset:13472
    v_cvt_pk_bf16_f32 v168, v160, v161
    v_mfma_f32_16x16x32_bf16 v[192:195], a[76:79], a[60:63], v[220:223]
    v_exp_f32 v178, v178
    v_mfma_f32_16x16x32_bf16 v[192:195], a[72:75], a[56:59], v[192:195]
    s_cmp_lt_u32 s27, 32
    s_cselect_b32 s45, s44, 0x100000
    v_mfma_f32_16x16x32_bf16 v[192:195], a[68:71], a[52:55], v[192:195]
    v_cvt_pk_bf16_f32 v176, v176, v177
    s_add_u32 m0, s24, s26
    v_mfma_f32_16x16x32_bf16 v[192:195], a[64:67], a[48:51], v[192:195]
    s_waitcnt vmcnt(8) lgkmcnt(0)
    v_mfma_f32_16x16x32_bf16 v[128:131], a[192:195], v[144:147], v[128:131]
    s_barrier
    v_add_u32 v224, s25, v226
    v_mfma_f32_16x16x32_bf16 v[128:131], a[192:195], v[148:151], v[128:131]
    v_exp_f32 v179, v179
    v_mfma_f32_16x16x32_bf16 v[28:31], a[188:191], v[148:151], v[28:31]
    ds_read_b128 a[64:67], v224 offset:0
    v_cvt_pk_bf16_f32 v177, v178, v179
    v_mfma_f32_16x16x32_bf16 v[28:31], a[184:187], v[144:147], v[28:31]
    v_exp_f32 v180, v180
    v_mfma_f32_16x16x32_bf16 v[24:27], a[176:179], v[144:147], v[24:27]
    v_exp_f32 v181, v181
    v_mfma_f32_16x16x32_bf16 v[24:27], a[180:183], v[148:151], v[24:27]
    buffer_load_dwordx4 v228, s[8:11], s45 offen offset:0 nt lds
    v_mfma_f32_16x16x32_bf16 v[20:23], a[172:175], v[148:151], v[20:23]
    v_exp_f32 v182, v182
    v_mfma_f32_16x16x32_bf16 v[20:23], a[168:171], v[144:147], v[20:23]
    ds_read_b128 a[68:71], v224 offset:256
    v_cvt_pk_bf16_f32 v178, v180, v181
    v_mfma_f32_16x16x32_bf16 v[16:19], a[160:163], v[144:147], v[16:19]
    v_exp_f32 v183, v183
    v_mfma_f32_16x16x32_bf16 v[16:19], a[164:167], v[148:151], v[16:19]
    v_exp_f32 v184, v184
    v_mfma_f32_16x16x32_bf16 v[12:15], a[156:159], v[148:151], v[12:15]
    ds_read_b128 a[72:75], v224 offset:512
    v_cvt_pk_bf16_f32 v179, v182, v183
    v_mfma_f32_16x16x32_bf16 v[12:15], a[152:155], v[144:147], v[12:15]
    v_exp_f32 v185, v185
    v_mfma_f32_16x16x32_bf16 v[8:11], a[144:147], v[144:147], v[8:11]
    v_exp_f32 v186, v186
    v_mfma_f32_16x16x32_bf16 v[8:11], a[148:151], v[148:151], v[8:11]
    ds_read_b128 a[76:79], v224 offset:768
    v_cvt_pk_bf16_f32 v180, v184, v185
    v_mfma_f32_16x16x32_bf16 v[4:7], a[140:143], v[148:151], v[4:7]
    v_exp_f32 v187, v187
    v_mfma_f32_16x16x32_bf16 v[4:7], a[136:139], v[144:147], v[4:7]
    v_exp_f32 v188, v188
    v_mfma_f32_16x16x32_bf16 v[0:3], a[128:131], v[144:147], v[0:3]
    v_exp_f32 v189, v189
    v_mfma_f32_16x16x32_bf16 v[0:3], a[132:135], v[148:151], v[0:3]
    buffer_load_dwordx4 v229, s[8:11], s45 offen offset:1056 nt lds
    v_mfma_f32_16x16x32_bf16 v[32:35], a[132:135], v[172:175], v[32:35]
    v_exp_f32 v190, v190
    v_mfma_f32_16x16x32_bf16 v[32:35], a[128:131], v[168:171], v[32:35]
    ds_read_b128 a[80:83], v224 offset:4224
    v_cvt_pk_bf16_f32 v181, v186, v187
    v_mfma_f32_16x16x32_bf16 v[36:39], a[136:139], v[168:171], v[36:39]
    v_exp_f32 v191, v191
    v_mfma_f32_16x16x32_bf16 v[36:39], a[140:143], v[172:175], v[36:39]
    v_exp_f32 v207, v207
    v_mfma_f32_16x16x32_bf16 v[40:43], a[148:151], v[172:175], v[40:43]
    ds_read_b128 a[84:87], v224 offset:4480
    v_cvt_pk_bf16_f32 v182, v188, v189
    v_mfma_f32_16x16x32_bf16 v[40:43], a[144:147], v[168:171], v[40:43]
    v_exp_f32 v206, v206
    v_mfma_f32_16x16x32_bf16 v[44:47], a[152:155], v[168:171], v[44:47]
    v_exp_f32 v205, v205
    v_mfma_f32_16x16x32_bf16 v[44:47], a[156:159], v[172:175], v[44:47]
    ds_read_b128 a[88:91], v224 offset:4736
    v_cvt_pk_bf16_f32 v183, v190, v191
    v_mfma_f32_16x16x32_bf16 v[48:51], a[164:167], v[172:175], v[48:51]
    v_exp_f32 v204, v204
    v_mfma_f32_16x16x32_bf16 v[48:51], a[160:163], v[168:171], v[48:51]
    v_exp_f32 v203, v203
    v_mfma_f32_16x16x32_bf16 v[52:55], a[168:171], v[168:171], v[52:55]
    v_cvt_pk_bf16_f32 v207, v206, v207
    v_cvt_pk_bf16_f32 v206, v204, v205
    v_mfma_f32_16x16x32_bf16 v[52:55], a[172:175], v[172:175], v[52:55]
    buffer_load_dwordx4 v230, s[8:11], s45 offen offset:2112 nt lds
    v_mfma_f32_16x16x32_bf16 v[56:59], a[180:183], v[172:175], v[56:59]
    v_exp_f32 v202, v202
    v_mfma_f32_16x16x32_bf16 v[56:59], a[176:179], v[168:171], v[56:59]
    ds_read_b128 a[92:95], v224 offset:4992
    v_cvt_pk_bf16_f32 v205, v202, v203
    v_mfma_f32_16x16x32_bf16 v[60:63], a[184:187], v[168:171], v[60:63]
    v_exp_f32 v201, v201
    v_mfma_f32_16x16x32_bf16 v[60:63], a[188:191], v[172:175], v[60:63]
    v_exp_f32 v200, v200
    v_mfma_f32_16x16x32_bf16 v[132:135], a[192:195], v[172:175], v[132:135]
    ds_read_b128 a[96:99], v224 offset:8448
    v_cvt_pk_bf16_f32 v204, v200, v201
    v_mfma_f32_16x16x32_bf16 v[132:135], a[192:195], v[168:171], v[132:135]
    v_exp_f32 v199, v199
    v_mfma_f32_16x16x32_bf16 v[136:139], a[192:195], v[176:179], v[136:139]
    v_exp_f32 v198, v198
    v_mfma_f32_16x16x32_bf16 v[136:139], a[192:195], v[180:183], v[136:139]
    ds_read_b128 a[100:103], v224 offset:8704
    v_cvt_pk_bf16_f32 v203, v198, v199
    v_mfma_f32_16x16x32_bf16 v[92:95], a[188:191], v[180:183], v[92:95]
    v_exp_f32 v197, v197
    v_mfma_f32_16x16x32_bf16 v[92:95], a[184:187], v[176:179], v[92:95]
    v_exp_f32 v196, v196
    v_mfma_f32_16x16x32_bf16 v[88:91], a[176:179], v[176:179], v[88:91]
    v_exp_f32 v195, v195
    v_mfma_f32_16x16x32_bf16 v[88:91], a[180:183], v[180:183], v[88:91]
    buffer_load_dwordx4 v231, s[8:11], s45 offen offset:3168 nt lds
    v_mfma_f32_16x16x32_bf16 v[84:87], a[172:175], v[180:183], v[84:87]
    v_exp_f32 v194, v194
    v_mfma_f32_16x16x32_bf16 v[84:87], a[168:171], v[176:179], v[84:87]
    ds_read_b128 a[104:107], v224 offset:8960
    v_cvt_pk_bf16_f32 v202, v196, v197
    v_mfma_f32_16x16x32_bf16 v[80:83], a[160:163], v[176:179], v[80:83]
    v_exp_f32 v193, v193
    v_mfma_f32_16x16x32_bf16 v[80:83], a[164:167], v[180:183], v[80:83]
    v_exp_f32 v192, v192
    v_mfma_f32_16x16x32_bf16 v[76:79], a[156:159], v[180:183], v[76:79]
    ds_read_b128 a[108:111], v224 offset:9216
    v_cvt_pk_bf16_f32 v201, v194, v195
    v_mfma_f32_16x16x32_bf16 v[76:79], a[152:155], v[176:179], v[76:79]
    v_cvt_pk_bf16_f32 v200, v192, v193
    v_mfma_f32_16x16x32_bf16 v[72:75], a[144:147], v[176:179], v[72:75]
    v_mfma_f32_16x16x32_bf16 v[72:75], a[148:151], v[180:183], v[72:75]
    ds_read_b128 a[112:115], v224 offset:12672
    v_mfma_f32_16x16x32_bf16 v[68:71], a[140:143], v[180:183], v[68:71]
    v_mfma_f32_16x16x32_bf16 v[68:71], a[136:139], v[176:179], v[68:71]
    v_mfma_f32_16x16x32_bf16 v[64:67], a[128:131], v[176:179], v[64:67]
    ds_read_b128 a[116:119], v224 offset:12928
    v_mfma_f32_16x16x32_bf16 v[64:67], a[132:135], v[180:183], v[64:67]
    ds_read_b128 a[120:123], v224 offset:13184
    v_mfma_f32_16x16x32_bf16 v[96:99], a[132:135], v[204:207], v[96:99]
    ds_read_b128 a[124:127], v224 offset:13440
    v_mfma_f32_16x16x32_bf16 v[96:99], a[128:131], v[200:203], v[96:99]
    v_add_u32 v225, s25, v227
    v_mfma_f32_16x16x32_bf16 v[100:103], a[136:139], v[200:203], v[100:103]
    ds_read_b64_tr_b16 a[128:129], v225 offset:0
    s_mov_b32 s24, s35
    v_mfma_f32_16x16x32_bf16 v[100:103], a[140:143], v[204:207], v[100:103]
    ds_read_b64_tr_b16 a[130:131], v225 offset:4224
    s_mov_b32 s35, s25
    v_mfma_f32_16x16x32_bf16 v[104:107], a[148:151], v[204:207], v[104:107]
    ds_read_b64_tr_b16 a[132:133], v225 offset:8448
    s_add_u32 s25, s25, 33792
    v_mfma_f32_16x16x32_bf16 v[104:107], a[144:147], v[200:203], v[104:107]
    ds_read_b64_tr_b16 a[134:135], v225 offset:12672
    s_cmp_eq_u32 s25, 135168
    v_mfma_f32_16x16x32_bf16 v[108:111], a[152:155], v[200:203], v[108:111]
    ds_read_b64_tr_b16 a[136:137], v225 offset:32
    s_cselect_b32 s25, 0, s25
    v_mfma_f32_16x16x32_bf16 v[108:111], a[156:159], v[204:207], v[108:111]
    ds_read_b64_tr_b16 a[138:139], v225 offset:4256
    v_mfma_f32_16x16x32_bf16 v[112:115], a[164:167], v[204:207], v[112:115]
    ds_read_b64_tr_b16 a[140:141], v225 offset:8480
    v_mfma_f32_16x16x32_bf16 v[112:115], a[160:163], v[200:203], v[112:115]
    ds_read_b64_tr_b16 a[142:143], v225 offset:12704
    v_mfma_f32_16x16x32_bf16 v[116:119], a[168:171], v[200:203], v[116:119]
    ds_read_b64_tr_b16 a[144:145], v225 offset:256
    v_mfma_f32_16x16x32_bf16 v[116:119], a[172:175], v[204:207], v[116:119]
    ds_read_b64_tr_b16 a[146:147], v225 offset:4480
    v_mfma_f32_16x16x32_bf16 v[120:123], a[180:183], v[204:207], v[120:123]
    ds_read_b64_tr_b16 a[148:149], v225 offset:8704
    v_mfma_f32_16x16x32_bf16 v[120:123], a[176:179], v[200:203], v[120:123]
    ds_read_b64_tr_b16 a[150:151], v225 offset:12928
    v_mfma_f32_16x16x32_bf16 v[124:127], a[184:187], v[200:203], v[124:127]
    ds_read_b64_tr_b16 a[152:153], v225 offset:288
    v_mfma_f32_16x16x32_bf16 v[124:127], a[188:191], v[204:207], v[124:127]
    ds_read_b64_tr_b16 a[154:155], v225 offset:4512
    v_mfma_f32_16x16x32_bf16 v[140:143], a[192:195], v[204:207], v[140:143]
    ds_read_b64_tr_b16 a[156:157], v225 offset:8736
    s_cmp_lt_u32 s27, 33
    v_mfma_f32_16x16x32_bf16 v[140:143], a[192:195], v[200:203], v[140:143]
    s_cbranch_scc1 L_loop0
    s_branch L_tail
.p2align 6
L_loop1:
    s_waitcnt lgkmcnt(14)
    v_mfma_f32_16x16x32_bf16 v[144:147], a[64:67], a[0:3], v[208:211]
    ds_read_b64_tr_b16 a[158:159], v225 offset:12960
    s_add_u32 m0, m0, 16896
    v_mfma_f32_16x16x32_bf16 v[144:147], a[68:71], a[4:7], v[144:147]
    ds_read_b64_tr_b16 a[160:161], v225 offset:512
    v_mfma_f32_16x16x32_bf16 v[144:147], a[72:75], a[8:11], v[144:147]
    ds_read_b64_tr_b16 a[162:163], v225 offset:4736
    v_mfma_f32_16x16x32_bf16 v[144:147], a[76:79], a[12:15], v[144:147]
    ds_read_b64_tr_b16 a[164:165], v225 offset:8960
    s_or_b32 s44, s44, 0x1e000
    v_mfma_f32_16x16x32_bf16 v[148:151], a[92:95], a[12:15], v[208:211]
    ds_read_b64_tr_b16 a[166:167], v225 offset:13184
    s_add_u32 s44, s44, 0x400
    v_mfma_f32_16x16x32_bf16 v[148:151], a[88:91], a[8:11], v[148:151]
    ds_read_b64_tr_b16 a[168:169], v225 offset:544
    s_and_b32 s44, s44, 0x61c00
    v_mfma_f32_16x16x32_bf16 v[148:151], a[84:87], a[4:7], v[148:151]
    ds_read_b64_tr_b16 a[170:171], v225 offset:4768
    s_add_u32 s27, s27, 1
    v_mfma_f32_16x16x32_bf16 v[148:151], a[80:83], a[0:3], v[148:151]
    ds_read_b64_tr_b16 a[172:173], v225 offset:8992
    v_mfma_f32_16x16x32_bf16 v[152:155], a[96:99], a[0:3], v[208:211]
    v_exp_f32 v144, v144
    v_mfma_f32_16x16x32_bf16 v[152:155], a[100:103], a[4:7], v[152:155]
    v_exp_f32 v145, v145
    v_mfma_f32_16x16x32_bf16 v[152:155], a[104:107], a[8:11], v[152:155]
    v_exp_f32 v146, v146
    v_mfma_f32_16x16x32_bf16 v[152:155], a[108:111], a[12:15], v[152:155]
    v_exp_f32 v147, v147
    v_mfma_f32_16x16x32_bf16 v[156:159], a[124:127], a[12:15], v[208:211]
    buffer_load_dwordx4 v228, s[12:15], s45 offen offset:0 nt lds
    v_mfma_f32_16x16x32_bf16 v[156:159], a[120:123], a[8:11], v[156:159]
    v_exp_f32 v148, v148
    v_mfma_f32_16x16x32_bf16 v[156:159], a[116:119], a[4:7], v[156:159]
    v_cvt_pk_bf16_f32 v144, v144, v145
    v_cvt_pk_bf16_f32 v145, v146, v147
    v_mfma_f32_16x16x32_bf16 v[156:159], a[112:115], a[0:3], v[156:159]
    ds_read_b64_tr_b16 a[174:175], v225 offset:13216
    v_mfma_f32_16x16x32_bf16 v[172:175], a[112:115], a[16:19], v[212:215]
    v_exp_f32 v149, v149
    v_mfma_f32_16x16x32_bf16 v[172:175], a[116:119], a[20:23], v[172:175]
    v_exp_f32 v150, v150
    v_mfma_f32_16x16x32_bf16 v[172:175], a[120:123], a[24:27], v[172:175]
    v_exp_f32 v151, v151
    v_mfma_f32_16x16x32_bf16 v[172:175], a[124:127], a[28:31], v[172:175]
    v_exp_f32 v152, v152
    v_mfma_f32_16x16x32_bf16 v[168:171], a[108:111], a[28:31], v[212:215]
    buffer_load_dwordx4 v229, s[12:15], s45 offen offset:1056 nt lds
    v_mfma_f32_16x16x32_bf16 v[168:171], a[104:107], a[24:27], v[168:171]
    v_cvt_pk_bf16_f32 v146, v148, v149
    v_cvt_pk_bf16_f32 v147, v150, v151
    v_mfma_f32_16x16x32_bf16 v[168:171], a[100:103], a[20:23], v[168:171]
    v_exp_f32 v153, v153
    v_mfma_f32_16x16x32_bf16 v[168:171], a[96:99], a[16:19], v[168:171]
    ds_read_b64_tr_b16 a[176:177], v225 offset:768
    v_cvt_pk_bf16_f32 v148, v152, v153
    v_mfma_f32_16x16x32_bf16 v[164:167], a[80:83], a[16:19], v[212:215]
    v_exp_f32 v154, v154
    v_mfma_f32_16x16x32_bf16 v[164:167], a[84:87], a[20:23], v[164:167]
    v_exp_f32 v155, v155
    v_mfma_f32_16x16x32_bf16 v[164:167], a[88:91], a[24:27], v[164:167]
    v_exp_f32 v156, v156
    v_mfma_f32_16x16x32_bf16 v[164:167], a[92:95], a[28:31], v[164:167]
    v_exp_f32 v157, v157
    v_mfma_f32_16x16x32_bf16 v[160:163], a[76:79], a[28:31], v[212:215]
    buffer_load_dwordx4 v230, s[12:15], s45 offen offset:2112 nt lds
    v_mfma_f32_16x16x32_bf16 v[160:163], a[72:75], a[24:27], v[160:163]
    v_exp_f32 v158, v158
    v_mfma_f32_16x16x32_bf16 v[160:163], a[68:71], a[20:23], v[160:163]
    v_cvt_pk_bf16_f32 v149, v154, v155
    v_cvt_pk_bf16_f32 v150, v156, v157
    v_mfma_f32_16x16x32_bf16 v[160:163], a[64:67], a[16:19], v[160:163]
    ds_read_b64_tr_b16 a[178:179], v225 offset:4992
    v_mfma_f32_16x16x32_bf16 v[176:179], a[64:67], a[32:35], v[216:219]
    v_exp_f32 v159, v159
    v_mfma_f32_16x16x32_bf16 v[176:179], a[68:71], a[36:39], v[176:179]
    v_exp_f32 v175, v175
    v_mfma_f32_16x16x32_bf16 v[176:179], a[72:75], a[40:43], v[176:179]
    v_exp_f32 v174, v174
    v_mfma_f32_16x16x32_bf16 v[176:179], a[76:79], a[44:47], v[176:179]
    v_exp_f32 v173, v173
    v_mfma_f32_16x16x32_bf16 v[180:183], a[92:95], a[44:47], v[216:219]
    buffer_load_dwordx4 v231, s[12:15], s45 offen offset:3168 nt lds
    v_mfma_f32_16x16x32_bf16 v[180:183], a[88:91], a[40:43], v[180:183]
    v_cvt_pk_bf16_f32 v151, v158, v159
    v_cvt_pk_bf16_f32 v175, v174, v175
    v_mfma_f32_16x16x32_bf16 v[180:183], a[84:87], a[36:39], v[180:183]
    v_exp_f32 v172, v172
    v_mfma_f32_16x16x32_bf16 v[180:183], a[80:83], a[32:35], v[180:183]
    ds_read_b64_tr_b16 a[180:181], v225 offset:9216
    v_cvt_pk_bf16_f32 v174, v172, v173
    v_mfma_f32_16x16x32_bf16 v[184:187], a[96:99], a[32:35], v[216:219]
    v_exp_f32 v171, v171
    v_mfma_f32_16x16x32_bf16 v[184:187], a[100:103], a[36:39], v[184:187]
    v_exp_f32 v170, v170
    v_mfma_f32_16x16x32_bf16 v[184:187], a[104:107], a[40:43], v[184:187]
    v_exp_f32 v169, v169
    v_mfma_f32_16x16x32_bf16 v[184:187], a[108:111], a[44:47], v[184:187]
    ds_read_b64_tr_b16 a[182:183], v225 offset:13440
    v_cvt_pk_bf16_f32 v173, v170, v171
    v_mfma_f32_16x16x32_bf16 v[188:191], a[124:127], a[44:47], v[216:219]
    v_exp_f32 v168, v168
    v_mfma_f32_16x16x32_bf16 v[188:191], a[120:123], a[40:43], v[188:191]
    v_exp_f32 v167, v167
    v_mfma_f32_16x16x32_bf16 v[188:191], a[116:119], a[36:39], v[188:191]
    v_exp_f32 v166, v166
    v_mfma_f32_16x16x32_bf16 v[188:191], a[112:115], a[32:35], v[188:191]
    ds_read_b64_tr_b16 a[184:185], v225 offset:800
    v_cvt_pk_bf16_f32 v172, v168, v169
    v_mfma_f32_16x16x32_bf16 v[204:207], a[112:115], a[48:51], v[220:223]
    v_exp_f32 v165, v165
    v_mfma_f32_16x16x32_bf16 v[204:207], a[116:119], a[52:55], v[204:207]
    v_exp_f32 v164, v164
    v_mfma_f32_16x16x32_bf16 v[204:207], a[120:123], a[56:59], v[204:207]
    v_exp_f32 v163, v163
    v_mfma_f32_16x16x32_bf16 v[204:207], a[124:127], a[60:63], v[204:207]
    ds_read_b64_tr_b16 a[186:187], v225 offset:5024
    v_cvt_pk_bf16_f32 v171, v166, v167
    v_mfma_f32_16x16x32_bf16 v[200:203], a[108:111], a[60:63], v[220:223]
    v_exp_f32 v162, v162
    v_mfma_f32_16x16x32_bf16 v[200:203], a[104:107], a[56:59], v[200:203]
    v_exp_f32 v161, v161
    v_mfma_f32_16x16x32_bf16 v[200:203], a[100:103], a[52:55], v[200:203]
    v_cvt_pk_bf16_f32 v170, v164, v165
    v_cvt_pk_bf16_f32 v169, v162, v163
    v_mfma_f32_16x16x32_bf16 v[200:203], a[96:99], a[48:51], v[200:203]
    ds_read_b64_tr_b16 a[188:189], v225 offset:9248
    v_mfma_f32_16x16x32_bf16 v[196:199], a[80:83], a[48:51], v[220:223]
    v_exp_f32 v160, v160
    v_mfma_f32_16x16x32_bf16 v[196:199], a[84:87], a[52:55], v[196:199]
    v_exp_f32 v176, v176
    v_mfma_f32_16x16x32_bf16 v[196:199], a[88:91], a[56:59], v[196:199]
    v_exp_f32 v177, v177
    v_mfma_f32_16x16x32_bf16 v[196:199], a[92:95], a[60:63], v[196:199]
    ds_read_b64_tr_b16 a[190:191], v225 offset:13472
    v_cvt_pk_bf16_f32 v168, v160, v161
    v_mfma_f32_16x16x32_bf16 v[192:195], a[76:79], a[60:63], v[220:223]
    v_exp_f32 v178, v178
    v_mfma_f32_16x16x32_bf16 v[192:195], a[72:75], a[56:59], v[192:195]
    s_cmp_lt_u32 s27, 32
    s_cselect_b32 s45, s44, 0x100000
    v_mfma_f32_16x16x32_bf16 v[192:195], a[68:71], a[52:55], v[192:195]
    v_cvt_pk_bf16_f32 v176, v176, v177
    s_add_u32 m0, s24, s26
    v_mfma_f32_16x16x32_bf16 v[192:195], a[64:67], a[48:51], v[192:195]
    s_waitcnt vmcnt(8) lgkmcnt(0)
    v_mfma_f32_16x16x32_bf16 v[128:131], a[192:195], v[144:147], v[128:131]
    s_barrier
    v_add_u32 v224, s25, v226
    v_mfma_f32_16x16x32_bf16 v[128:131], a[192:195], v[148:151], v[128:131]
    v_exp_f32 v179, v179
    v_mfma_f32_16x16x32_bf16 v[28:31], a[188:191], v[148:151], v[28:31]
    ds_read_b128 a[64:67], v224 offset:0
    v_cvt_pk_bf16_f32 v177, v178, v179
    v_mfma_f32_16x16x32_bf16 v[28:31], a[184:187], v[144:147], v[28:31]
    v_exp_f32 v180, v180
    v_mfma_f32_16x16x32_bf16 v[24:27], a[176:179], v[144:147], v[24:27]
    v_exp_f32 v181, v181
    v_mfma_f32_16x16x32_bf16 v[24:27], a[180:183], v[148:151], v[24:27]
    v_exp_f32 v182, v182
    v_mfma_f32_16x16x32_bf16 v[20:23], a[172:175], v[148:151], v[20:23]
    buffer_load_dwordx4 v228, s[8:11], s45 offen offset:0 nt lds
    v_mfma_f32_16x16x32_bf16 v[20:23], a[168:171], v[144:147], v[20:23]
    ds_read_b128 a[68:71], v224 offset:256
    v_cvt_pk_bf16_f32 v178, v180, v181
    v_mfma_f32_16x16x32_bf16 v[16:19], a[160:163], v[144:147], v[16:19]
    v_exp_f32 v183, v183
    v_mfma_f32_16x16x32_bf16 v[16:19], a[164:167], v[148:151], v[16:19]
    v_exp_f32 v184, v184
    v_mfma_f32_16x16x32_bf16 v[12:15], a[156:159], v[148:151], v[12:15]
    ds_read_b128 a[72:75], v224 offset:512
    v_cvt_pk_bf16_f32 v179, v182, v183
    v_mfma_f32_16x16x32_bf16 v[12:15], a[152:155], v[144:147], v[12:15]
    v_exp_f32 v185, v185
    v_mfma_f32_16x16x32_bf16 v[8:11], a[144:147], v[144:147], v[8:11]
    v_exp_f32 v186, v186
    v_mfma_f32_16x16x32_bf16 v[8:11], a[148:151], v[148:151], v[8:11]
    ds_read_b128 a[76:79], v224 offset:768
    v_cvt_pk_bf16_f32 v180, v184, v185
    v_mfma_f32_16x16x32_bf16 v[4:7], a[140:143], v[148:151], v[4:7]
    v_exp_f32 v187, v187
    v_mfma_f32_16x16x32_bf16 v[4:7], a[136:139], v[144:147], v[4:7]
    v_exp_f32 v188, v188
    v_mfma_f32_16x16x32_bf16 v[0:3], a[128:131], v[144:147], v[0:3]
    v_exp_f32 v189, v189
    v_mfma_f32_16x16x32_bf16 v[0:3], a[132:135], v[148:151], v[0:3]
    v_exp_f32 v190, v190
    v_mfma_f32_16x16x32_bf16 v[32:35], a[132:135], v[172:175], v[32:35]
    buffer_load_dwordx4 v229, s[8:11], s45 offen offset:1056 nt lds
    v_mfma_f32_16x16x32_bf16 v[32:35], a[128:131], v[168:171], v[32:35]
    ds_read_b128 a[80:83], v224 offset:4224
    v_cvt_pk_bf16_f32 v181, v186, v187
    v_mfma_f32_16x16x32_bf16 v[36:39], a[136:139], v[168:171], v[36:39]
    v_exp_f32 v191, v191
    v_mfma_f32_16x16x32_bf16 v[36:39], a[140:143], v[172:175], v[36:39]
    v_exp_f32 v207, v207
    v_mfma_f32_16x16x32_bf16 v[40:43], a[148:151], v[172:175], v[40:43]
    ds_read_b128 a[84:87], v224 offset:4480
    v_cvt_pk_bf16_f32 v182, v188, v189
    v_mfma_f32_16x16x32_bf16 v[40:43], a[144:147], v[168:171], v[40:43]
    v_exp_f32 v206, v206
    v_mfma_f32_16x16x32_bf16 v[44:47], a[152:155], v[168:171], v[44:47]
    v_exp_f32 v205, v205
    v_mfma_f32_16x16x32_bf16 v[44:47], a[156:159], v[172:175], v[44:47]
    ds_read_b128 a[88:91], v224 offset:4736
    v_cvt_pk_bf16_f32 v183, v190, v191
    v_mfma_f32_16x16x32_bf16 v[48:51], a[164:167], v[172:175], v[48:51]
    v_exp_f32 v204, v204
    v_mfma_f32_16x16x32_bf16 v[48:51], a[160:163], v[168:171], v[48:51]
    v_exp_f32 v203, v203
    v_mfma_f32_16x16x32_bf16 v[52:55], a[168:171], v[168:171], v[52:55]
    v_cvt_pk_bf16_f32 v207, v206, v207
    v_cvt_pk_bf16_f32 v206, v204, v205
    v_mfma_f32_16x16x32_bf16 v[52:55], a[172:175], v[172:175], v[52:55]
    v_exp_f32 v202, v202
    v_mfma_f32_16x16x32_bf16 v[56:59], a[180:183], v[172:175], v[56:59]
    buffer_load_dwordx4 v230, s[8:11], s45 offen offset:2112 nt lds
    v_mfma_f32_16x16x32_bf16 v[56:59], a[176:179], v[168:171], v[56:59]
    ds_read_b128 a[92:95], v224 offset:4992
    v_cvt_pk_bf16_f32 v205, v202, v203
    v_mfma_f32_16x16x32_bf16 v[60:63], a[184:187], v[168:171], v[60:63]
    v_exp_f32 v201, v201
    v_mfma_f32_16x16x32_bf16 v[60:63], a[188:191], v[172:175], v[60:63]
    v_exp_f32 v200, v200
    v_mfma_f32_16x16x32_bf16 v[132:135], a[192:195], v[172:175], v[132:135]
    ds_read_b128 a[96:99], v224 offset:8448
    v_cvt_pk_bf16_f32 v204, v200, v201
    v_mfma_f32_16x16x32_bf16 v[132:135], a[192:195], v[168:171], v[132:135]
    v_exp_f32 v199, v199
    v_mfma_f32_16x16x32_bf16 v[136:139], a[192:195], v[176:179], v[136:139]
    v_exp_f32 v198, v198
    v_mfma_f32_16x16x32_bf16 v[136:139], a[192:195], v[180:183], v[136:139]
    ds_read_b128 a[100:103], v224 offset:8704
    v_cvt_pk_bf16_f32 v203, v198, v199
    v_mfma_f32_16x16x32_bf16 v[92:95], a[188:191], v[180:183], v[92:95]
    v_exp_f32 v197, v197
    v_mfma_f32_16x16x32_bf16 v[92:95], a[184:187], v[176:179], v[92:95]
    v_exp_f32 v196, v196
    v_mfma_f32_16x16x32_bf16 v[88:91], a[176:179], v[176:179], v[88:91]
    v_exp_f32 v195, v195
    v_mfma_f32_16x16x32_bf16 v[88:91], a[180:183], v[180:183], v[88:91]
    v_exp_f32 v194, v194
    v_mfma_f32_16x16x32_bf16 v[84:87], a[172:175], v[180:183], v[84:87]
    buffer_load_dwordx4 v231, s[8:11], s45 offen offset:3168 nt lds
    v_mfma_f32_16x16x32_bf16 v[84:87], a[168:171], v[176:179], v[84:87]
    ds_read_b128 a[104:107], v224 offset:8960
    v_cvt_pk_bf16_f32 v202, v196, v197
    v_mfma_f32_16x16x32_bf16 v[80:83], a[160:163], v[176:179], v[80:83]
    v_exp_f32 v193, v193
    v_mfma_f32_16x16x32_bf16 v[80:83], a[164:167], v[180:183], v[80:83]
    v_exp_f32 v192, v192
    v_mfma_f32_16x16x32_bf16 v[76:79], a[156:159], v[180:183], v[76:79]
    ds_read_b128 a[108:111], v224 offset:9216
    v_cvt_pk_bf16_f32 v201, v194, v195
    v_mfma_f32_16x16x32_bf16 v[76:79], a[152:155], v[176:179], v[76:79]
    v_cvt_pk_bf16_f32 v200, v192, v193
    v_mfma_f32_16x16x32_bf16 v[72:75], a[144:147], v[176:179], v[72:75]
    v_mfma_f32_16x16x32_bf16 v[72:75], a[148:151], v[180:183], v[72:75]
    ds_read_b128 a[112:115], v224 offset:12672
    v_mfma_f32_16x16x32_bf16 v[68:71], a[140:143], v[180:183], v[68:71]
    v_mfma_f32_16x16x32_bf16 v[68:71], a[136:139], v[176:179], v[68:71]
    v_mfma_f32_16x16x32_bf16 v[64:67], a[128:131], v[176:179], v[64:67]
    ds_read_b128 a[116:119], v224 offset:12928
    v_mfma_f32_16x16x32_bf16 v[64:67], a[132:135], v[180:183], v[64:67]
    ds_read_b128 a[120:123], v224 offset:13184
    v_mfma_f32_16x16x32_bf16 v[96:99], a[132:135], v[204:207], v[96:99]
    ds_read_b128 a[124:127], v224 offset:13440
    v_mfma_f32_16x16x32_bf16 v[96:99], a[128:131], v[200:203], v[96:99]
    v_add_u32 v225, s25, v227
    v_mfma_f32_16x16x32_bf16 v[100:103], a[136:139], v[200:203], v[100:103]
    ds_read_b64_tr_b16 a[128:129], v225 offset:0
    s_mov_b32 s24, s35
    v_mfma_f32_16x16x32_bf16 v[100:103], a[140:143], v[204:207], v[100:103]
    ds_read_b64_tr_b16 a[130:131], v225 offset:4224
    s_mov_b32 s35, s25
    v_mfma_f32_16x16x32_bf16 v[104:107], a[148:151], v[204:207], v[104:107]
    ds_read_b64_tr_b16 a[132:133], v225 offset:8448
    s_add_u32 s25, s25, 33792
    v_mfma_f32_16x16x32_bf16 v[104:107], a[144:147], v[200:203], v[104:107]
    ds_read_b64_tr_b16 a[134:135], v225 offset:12672
    s_cmp_eq_u32 s25, 135168
    v_mfma_f32_16x16x32_bf16 v[108:111], a[152:155], v[200:203], v[108:111]
    ds_read_b64_tr_b16 a[136:137], v225 offset:32
    s_cselect_b32 s25, 0, s25
    v_mfma_f32_16x16x32_bf16 v[108:111], a[156:159], v[204:207], v[108:111]
    ds_read_b64_tr_b16 a[138:139], v225 offset:4256
    v_mfma_f32_16x16x32_bf16 v[112:115], a[164:167], v[204:207], v[112:115]
    ds_read_b64_tr_b16 a[140:141], v225 offset:8480
    v_mfma_f32_16x16x32_bf16 v[112:115], a[160:163], v[200:203], v[112:115]
    ds_read_b64_tr_b16 a[142:143], v225 offset:12704
    v_mfma_f32_16x16x32_bf16 v[116:119], a[168:171], v[200:203], v[116:119]
    ds_read_b64_tr_b16 a[144:145], v225 offset:256
    v_mfma_f32_16x16x32_bf16 v[116:119], a[172:175], v[204:207], v[116:119]
    ds_read_b64_tr_b16 a[146:147], v225 offset:4480
    v_mfma_f32_16x16x32_bf16 v[120:123], a[180:183], v[204:207], v[120:123]
    ds_read_b64_tr_b16 a[148:149], v225 offset:8704
    v_mfma_f32_16x16x32_bf16 v[120:123], a[176:179], v[200:203], v[120:123]
    ds_read_b64_tr_b16 a[150:151], v225 offset:12928
    v_mfma_f32_16x16x32_bf16 v[124:127], a[184:187], v[200:203], v[124:127]
    ds_read_b64_tr_b16 a[152:153], v225 offset:288
    v_mfma_f32_16x16x32_bf16 v[124:127], a[188:191], v[204:207], v[124:127]
    ds_read_b64_tr_b16 a[154:155], v225 offset:4512
    v_mfma_f32_16x16x32_bf16 v[140:143], a[192:195], v[204:207], v[140:143]
    ds_read_b64_tr_b16 a[156:157], v225 offset:8736
    s_cmp_lt_u32 s27, 33
    v_mfma_f32_16x16x32_bf16 v[140:143], a[192:195], v[200:203], v[140:143]
    s_cbranch_scc1 L_loop1
L_tail:
    s_waitcnt lgkmcnt(14)
    v_mfma_f32_16x16x32_bf16 v[144:147], a[64:67], a[0:3], v[208:211]
    ds_read_b64_tr_b16 a[190:191], v225 offset:13472
    s_mul_i32 s29, s28, 4352
    s_add_u32 s29, s29, 67584
    v_and_b32 v243, 15, v248
    v_mfma_f32_16x16x32_bf16 v[144:147], a[68:71], a[4:7], v[144:147]
    ds_read_b64_tr_b16 a[188:189], v225 offset:9248
    v_bfe_u32 v244, v248, 4, 2
    v_mul_u32_u24 v240, 272, v243
    v_lshl_add_u32 v240, v244, 3, v240
    v_mfma_f32_16x16x32_bf16 v[144:147], a[72:75], a[8:11], v[144:147]
    ds_read_b64_tr_b16 a[186:187], v225 offset:5024
    v_add_u32 v240, s29, v240
    v_mul_u32_u24 v241, 272, v244
    v_lshl_add_u32 v241, v243, 4, v241
    v_mfma_f32_16x16x32_bf16 v[144:147], a[76:79], a[12:15], v[144:147]
    ds_read_b64_tr_b16 a[184:185], v225 offset:800
    v_add_u32 v241, s29, v241
    v_and_b32 v242, 63, v248
    v_lshlrev_b32 v242, 4, v242
    v_mfma_f32_16x16x32_bf16 v[148:151], a[92:95], a[12:15], v[208:211]
    ds_read_b64_tr_b16 a[182:183], v225 offset:13440
    s_lshl_b32 s36, s28, 14
    s_add_u32 s37, s36, 4096
    s_add_u32 s38, s37, 4096
    v_mfma_f32_16x16x32_bf16 v[148:151], a[88:91], a[8:11], v[148:151]
    ds_read_b64_tr_b16 a[180:181], v225 offset:9216
    s_add_u32 s39, s38, 4096
    v_mfma_f32_16x16x32_bf16 v[148:151], a[84:87], a[4:7], v[148:151]
    ds_read_b64_tr_b16 a[178:179], v225 offset:4992
    v_mfma_f32_16x16x32_bf16 v[148:151], a[80:83], a[0:3], v[148:151]
    ds_read_b64_tr_b16 a[176:177], v225 offset:768
    v_exp_f32 v144, v144
    v_exp_f32 v145, v145
    v_mfma_f32_16x16x32_bf16 v[152:155], a[96:99], a[0:3], v[208:211]
    ds_read_b64_tr_b16 a[174:175], v225 offset:13216
    v_exp_f32 v146, v146
    v_exp_f32 v147, v147
    v_mfma_f32_16x16x32_bf16 v[152:155], a[100:103], a[4:7], v[152:155]
    ds_read_b64_tr_b16 a[172:173], v225 offset:8992
    v_mfma_f32_16x16x32_bf16 v[152:155], a[104:107], a[8:11], v[152:155]
    ds_read_b64_tr_b16 a[170:171], v225 offset:4768
    v_mfma_f32_16x16x32_bf16 v[152:155], a[108:111], a[12:15], v[152:155]
    ds_read_b64_tr_b16 a[168:169], v225 offset:544
    v_exp_f32 v148, v148
    v_exp_f32 v149, v149
    v_mfma_f32_16x16x32_bf16 v[156:159], a[124:127], a[12:15], v[208:211]
    ds_read_b64_tr_b16 a[166:167], v225 offset:13184
    v_exp_f32 v150, v150
    v_exp_f32 v151, v151
    v_mfma_f32_16x16x32_bf16 v[156:159], a[120:123], a[8:11], v[156:159]
    ds_read_b64_tr_b16 a[164:165], v225 offset:8960
    v_cvt_pk_bf16_f32 v144, v144, v145
    v_cvt_pk_bf16_f32 v145, v146, v147
    v_mfma_f32_16x16x32_bf16 v[156:159], a[116:119], a[4:7], v[156:159]
    ds_read_b64_tr_b16 a[162:163], v225 offset:4736
    v_mfma_f32_16x16x32_bf16 v[156:159], a[112:115], a[0:3], v[156:159]
    ds_read_b64_tr_b16 a[160:161], v225 offset:512
    v_exp_f32 v152, v152
    v_exp_f32 v153, v153
    v_mfma_f32_16x16x32_bf16 v[172:175], a[112:115], a[16:19], v[212:215]
    ds_read_b64_tr_b16 a[158:159], v225 offset:12960
    v_exp_f32 v154, v154
    v_exp_f32 v155, v155
    v_mfma_f32_16x16x32_bf16 v[172:175], a[116:119], a[20:23], v[172:175]
    v_cvt_pk_bf16_f32 v146, v148, v149
    v_cvt_pk_bf16_f32 v147, v150, v151
    v_mfma_f32_16x16x32_bf16 v[172:175], a[120:123], a[24:27], v[172:175]
    v_mfma_f32_16x16x32_bf16 v[172:175], a[124:127], a[28:31], v[172:175]
    v_exp_f32 v156, v156
    v_exp_f32 v157, v157
    v_mfma_f32_16x16x32_bf16 v[168:171], a[108:111], a[28:31], v[212:215]
    v_exp_f32 v158, v158
    v_exp_f32 v159, v159
    v_mfma_f32_16x16x32_bf16 v[168:171], a[104:107], a[24:27], v[168:171]
    v_cvt_pk_bf16_f32 v148, v152, v153
    v_cvt_pk_bf16_f32 v149, v154, v155
    v_cvt_pk_bf16_f32 v150, v156, v157
    v_cvt_pk_bf16_f32 v151, v158, v159
    v_mfma_f32_16x16x32_bf16 v[168:171], a[100:103], a[20:23], v[168:171]
    v_mfma_f32_16x16x32_bf16 v[168:171], a[96:99], a[16:19], v[168:171]
    v_exp_f32 v175, v175
    v_exp_f32 v174, v174
    v_mfma_f32_16x16x32_bf16 v[164:167], a[80:83], a[16:19], v[212:215]
    v_exp_f32 v173, v173
    v_exp_f32 v172, v172
    v_mfma_f32_16x16x32_bf16 v[164:167], a[84:87], a[20:23], v[164:167]
    v_mfma_f32_16x16x32_bf16 v[164:167], a[88:91], a[24:27], v[164:167]
    v_mfma_f32_16x16x32_bf16 v[164:167], a[92:95], a[28:31], v[164:167]
    v_exp_f32 v171, v171
    v_exp_f32 v170, v170
    v_mfma_f32_16x16x32_bf16 v[160:163], a[76:79], a[28:31], v[212:215]
    v_exp_f32 v169, v169
    v_exp_f32 v168, v168
    v_mfma_f32_16x16x32_bf16 v[160:163], a[72:75], a[24:27], v[160:163]
    v_cvt_pk_bf16_f32 v175, v174, v175
    v_cvt_pk_bf16_f32 v174, v172, v173
    v_mfma_f32_16x16x32_bf16 v[160:163], a[68:71], a[20:23], v[160:163]
    v_mfma_f32_16x16x32_bf16 v[160:163], a[64:67], a[16:19], v[160:163]
    v_exp_f32 v167, v167
    v_exp_f32 v166, v166
    v_mfma_f32_16x16x32_bf16 v[128:131], a[192:195], v[144:147], v[128:131]
    v_exp_f32 v165, v165
    v_exp_f32 v164, v164
    v_mfma_f32_16x16x32_bf16 v[128:131], a[192:195], v[148:151], v[128:131]
    v_cvt_pk_bf16_f32 v173, v170, v171
    v_cvt_pk_bf16_f32 v172, v168, v169
    s_waitcnt lgkmcnt(14)
    v_mfma_f32_16x16x32_bf16 v[28:31], a[188:191], v[148:151], v[28:31]
    s_waitcnt lgkmcnt(13)
    v_mfma_f32_16x16x32_bf16 v[28:31], a[184:187], v[144:147], v[28:31]
    v_exp_f32 v163, v163
    v_exp_f32 v162, v162
    s_waitcnt lgkmcnt(9)
    v_mfma_f32_16x16x32_bf16 v[24:27], a[176:179], v[144:147], v[24:27]
    v_exp_f32 v161, v161
    v_exp_f32 v160, v160
    v_mfma_f32_16x16x32_bf16 v[24:27], a[180:183], v[148:151], v[24:27]
    v_cvt_pk_bf16_f32 v171, v166, v167
    v_cvt_pk_bf16_f32 v170, v164, v165
    v_cvt_pk_bf16_f32 v169, v162, v163
    v_cvt_pk_bf16_f32 v168, v160, v161
    s_waitcnt lgkmcnt(7)
    v_mfma_f32_16x16x32_bf16 v[20:23], a[172:175], v[148:151], v[20:23]
    v_rcp_f32 v232, v128
    s_nop 0
    s_waitcnt lgkmcnt(5)
    v_mfma_f32_16x16x32_bf16 v[20:23], a[168:171], v[144:147], v[20:23]
    v_mul_f32 v28, v28, v232
    v_mul_f32 v29, v29, v232
    v_mul_f32 v30, v30, v232
    v_mul_f32 v31, v31, v232
    s_waitcnt lgkmcnt(1)
    v_mfma_f32_16x16x32_bf16 v[16:19], a[160:163], v[144:147], v[16:19]
    v_cvt_pk_bf16_f32 v28, v28, v29
    v_cvt_pk_bf16_f32 v29, v30, v31
    v_mfma_f32_16x16x32_bf16 v[16:19], a[164:167], v[148:151], v[16:19]
    ds_write_b64 v240, v[28:29] offset:224
    v_mul_f32 v24, v24, v232
    v_mul_f32 v25, v25, v232
    v_mul_f32 v26, v26, v232
    s_waitcnt lgkmcnt(1)
    v_mfma_f32_16x16x32_bf16 v[12:15], a[156:159], v[148:151], v[12:15]
    v_mul_f32 v27, v27, v232
    v_cvt_pk_bf16_f32 v24, v24, v25
    v_cvt_pk_bf16_f32 v25, v26, v27
    v_mfma_f32_16x16x32_bf16 v[12:15], a[152:155], v[144:147], v[12:15]
    ds_write_b64 v240, v[24:25] offset:192
    v_mul_f32 v20, v20, v232
    v_mul_f32 v21, v21, v232
    v_mul_f32 v22, v22, v232
    v_mfma_f32_16x16x32_bf16 v[8:11], a[144:147], v[144:147], v[8:11]
    v_mul_f32 v23, v23, v232
    v_cvt_pk_bf16_f32 v20, v20, v21
    v_cvt_pk_bf16_f32 v21, v22, v23
    v_mfma_f32_16x16x32_bf16 v[8:11], a[148:151], v[148:151], v[8:11]
    ds_write_b64 v240, v[20:21] offset:160
    v_mul_f32 v16, v16, v232
    v_mul_f32 v17, v17, v232
    v_mul_f32 v18, v18, v232
    v_mfma_f32_16x16x32_bf16 v[4:7], a[140:143], v[148:151], v[4:7]
    v_mul_f32 v19, v19, v232
    v_cvt_pk_bf16_f32 v16, v16, v17
    v_cvt_pk_bf16_f32 v17, v18, v19
    v_mfma_f32_16x16x32_bf16 v[4:7], a[136:139], v[144:147], v[4:7]
    ds_write_b64 v240, v[16:17] offset:128
    v_mul_f32 v12, v12, v232
    v_mul_f32 v13, v13, v232
    v_mul_f32 v14, v14, v232
    v_mfma_f32_16x16x32_bf16 v[0:3], a[128:131], v[144:147], v[0:3]
    v_mul_f32 v15, v15, v232
    v_cvt_pk_bf16_f32 v12, v12, v13
    v_cvt_pk_bf16_f32 v13, v14, v15
    v_mfma_f32_16x16x32_bf16 v[0:3], a[132:135], v[148:151], v[0:3]
    ds_write_b64 v240, v[12:13] offset:96
    v_mul_f32 v8, v8, v232
    v_mul_f32 v9, v9, v232
    v_mul_f32 v10, v10, v232
    v_mfma_f32_16x16x32_bf16 v[176:179], a[64:67], a[32:35], v[216:219]
    v_mul_f32 v11, v11, v232
    v_cvt_pk_bf16_f32 v8, v8, v9
    v_cvt_pk_bf16_f32 v9, v10, v11
    v_mfma_f32_16x16x32_bf16 v[176:179], a[68:71], a[36:39], v[176:179]
    ds_write_b64 v240, v[8:9] offset:64
    v_mul_f32 v4, v4, v232
    v_mul_f32 v5, v5, v232
    v_mul_f32 v6, v6, v232
    v_mfma_f32_16x16x32_bf16 v[176:179], a[72:75], a[40:43], v[176:179]
    v_mul_f32 v7, v7, v232
    v_cvt_pk_bf16_f32 v4, v4, v5
    v_cvt_pk_bf16_f32 v5, v6, v7
    v_mfma_f32_16x16x32_bf16 v[176:179], a[76:79], a[44:47], v[176:179]
    ds_write_b64 v240, v[4:5] offset:32
    v_mul_f32 v0, v0, v232
    v_mul_f32 v1, v1, v232
    v_mul_f32 v2, v2, v232
    v_mfma_f32_16x16x32_bf16 v[180:183], a[92:95], a[44:47], v[216:219]
    v_mul_f32 v3, v3, v232
    v_cvt_pk_bf16_f32 v0, v0, v1
    v_cvt_pk_bf16_f32 v1, v2, v3
    v_mfma_f32_16x16x32_bf16 v[180:183], a[88:91], a[40:43], v[180:183]
    ds_write_b64 v240, v[0:1] offset:0
    v_mfma_f32_16x16x32_bf16 v[180:183], a[84:87], a[36:39], v[180:183]
    ds_read_b128 v[0:3], v241 offset:0
    v_mfma_f32_16x16x32_bf16 v[180:183], a[80:83], a[32:35], v[180:183]
    ds_read_b128 v[4:7], v241 offset:1088
    v_exp_f32 v176, v176
    v_exp_f32 v177, v177
    v_mfma_f32_16x16x32_bf16 v[184:187], a[96:99], a[32:35], v[216:219]
    ds_read_b128 v[8:11], v241 offset:2176
    v_exp_f32 v178, v178
    v_exp_f32 v179, v179
    v_mfma_f32_16x16x32_bf16 v[184:187], a[100:103], a[36:39], v[184:187]
    ds_read_b128 v[12:15], v241 offset:3264
    v_mfma_f32_16x16x32_bf16 v[184:187], a[104:107], a[40:43], v[184:187]
    v_mfma_f32_16x16x32_bf16 v[184:187], a[108:111], a[44:47], v[184:187]
    v_exp_f32 v180, v180
    v_exp_f32 v181, v181
    v_mfma_f32_16x16x32_bf16 v[188:191], a[124:127], a[44:47], v[216:219]
    v_exp_f32 v182, v182
    v_exp_f32 v183, v183
    v_mfma_f32_16x16x32_bf16 v[188:191], a[120:123], a[40:43], v[188:191]
    v_cvt_pk_bf16_f32 v176, v176, v177
    v_cvt_pk_bf16_f32 v177, v178, v179
    v_mfma_f32_16x16x32_bf16 v[188:191], a[116:119], a[36:39], v[188:191]
    s_waitcnt lgkmcnt(3)
    buffer_store_dwordx4 v[0:3], v242, s[20:23], s36 offen offset:0 sc1 nt
    v_mfma_f32_16x16x32_bf16 v[188:191], a[112:115], a[32:35], v[188:191]
    v_exp_f32 v184, v184
    v_exp_f32 v185, v185
    v_mfma_f32_16x16x32_bf16 v[132:135], a[192:195], v[172:175], v[132:135]
    v_exp_f32 v186, v186
    v_exp_f32 v187, v187
    v_mfma_f32_16x16x32_bf16 v[132:135], a[192:195], v[168:171], v[132:135]
    v_cvt_pk_bf16_f32 v178, v180, v181
    v_cvt_pk_bf16_f32 v179, v182, v183
    v_mfma_f32_16x16x32_bf16 v[32:35], a[128:131], v[168:171], v[32:35]
    s_waitcnt lgkmcnt(2)
    buffer_store_dwordx4 v[4:7], v242, s[20:23], s36 offen offset:1024 sc1 nt
    v_mfma_f32_16x16x32_bf16 v[32:35], a[132:135], v[172:175], v[32:35]
    v_exp_f32 v188, v188
    v_exp_f32 v189, v189
    v_mfma_f32_16x16x32_bf16 v[36:39], a[140:143], v[172:175], v[36:39]
    v_exp_f32 v190, v190
    v_exp_f32 v191, v191
    v_mfma_f32_16x16x32_bf16 v[36:39], a[136:139], v[168:171], v[36:39]
    v_cvt_pk_bf16_f32 v180, v184, v185
    v_cvt_pk_bf16_f32 v181, v186, v187
    v_cvt_pk_bf16_f32 v182, v188, v189
    v_cvt_pk_bf16_f32 v183, v190, v191
    v_mfma_f32_16x16x32_bf16 v[40:43], a[144:147], v[168:171], v[40:43]
    s_waitcnt lgkmcnt(1)
    buffer_store_dwordx4 v[8:11], v242, s[20:23], s36 offen offset:2048 sc1 nt
    v_rcp_f32 v234, v132
    v_mfma_f32_16x16x32_bf16 v[40:43], a[148:151], v[172:175], v[40:43]
    s_nop 0
    v_mul_f32 v32, v32, v234
    v_mul_f32 v33, v33, v234
    v_mul_f32 v34, v34, v234
    v_mfma_f32_16x16x32_bf16 v[44:47], a[156:159], v[172:175], v[44:47]
    v_mul_f32 v35, v35, v234
    v_cvt_pk_bf16_f32 v32, v32, v33
    v_cvt_pk_bf16_f32 v33, v34, v35
    v_mfma_f32_16x16x32_bf16 v[44:47], a[152:155], v[168:171], v[44:47]
    ds_write_b64 v240, v[32:33] offset:0
    v_mul_f32 v36, v36, v234
    v_mul_f32 v37, v37, v234
    v_mul_f32 v38, v38, v234
    v_mfma_f32_16x16x32_bf16 v[48:51], a[160:163], v[168:171], v[48:51]
    s_waitcnt lgkmcnt(1)
    buffer_store_dwordx4 v[12:15], v242, s[20:23], s36 offen offset:3072 sc1 nt
    v_mul_f32 v39, v39, v234
    v_cvt_pk_bf16_f32 v36, v36, v37
    v_mfma_f32_16x16x32_bf16 v[48:51], a[164:167], v[172:175], v[48:51]
    v_cvt_pk_bf16_f32 v37, v38, v39
    v_mul_f32 v40, v40, v234
    v_mul_f32 v41, v41, v234
    v_mul_f32 v42, v42, v234
    v_mfma_f32_16x16x32_bf16 v[52:55], a[172:175], v[172:175], v[52:55]
    ds_write_b64 v240, v[36:37] offset:32
    v_mul_f32 v43, v43, v234
    v_cvt_pk_bf16_f32 v40, v40, v41
    v_cvt_pk_bf16_f32 v41, v42, v43
    v_mfma_f32_16x16x32_bf16 v[52:55], a[168:171], v[168:171], v[52:55]
    ds_write_b64 v240, v[40:41] offset:64
    v_mul_f32 v44, v44, v234
    v_mul_f32 v45, v45, v234
    v_mul_f32 v46, v46, v234
    v_mfma_f32_16x16x32_bf16 v[56:59], a[176:179], v[168:171], v[56:59]
    v_mul_f32 v47, v47, v234
    v_cvt_pk_bf16_f32 v44, v44, v45
    v_cvt_pk_bf16_f32 v45, v46, v47
    v_mfma_f32_16x16x32_bf16 v[56:59], a[180:183], v[172:175], v[56:59]
    ds_write_b64 v240, v[44:45] offset:96
    v_mul_f32 v48, v48, v234
    v_mul_f32 v49, v49, v234
    v_mul_f32 v50, v50, v234
    v_mfma_f32_16x16x32_bf16 v[60:63], a[188:191], v[172:175], v[60:63]
    v_mul_f32 v51, v51, v234
    v_cvt_pk_bf16_f32 v48, v48, v49
    v_cvt_pk_bf16_f32 v49, v50, v51
    v_mfma_f32_16x16x32_bf16 v[60:63], a[184:187], v[168:171], v[60:63]
    ds_write_b64 v240, v[48:49] offset:128
    v_mul_f32 v52, v52, v234
    v_mul_f32 v53, v53, v234
    v_mul_f32 v54, v54, v234
    v_mfma_f32_16x16x32_bf16 v[204:207], a[112:115], a[48:51], v[220:223]
    v_mul_f32 v55, v55, v234
    v_cvt_pk_bf16_f32 v52, v52, v53
    v_cvt_pk_bf16_f32 v53, v54, v55
    v_mfma_f32_16x16x32_bf16 v[204:207], a[116:119], a[52:55], v[204:207]
    ds_write_b64 v240, v[52:53] offset:160
    v_mul_f32 v56, v56, v234
    v_mul_f32 v57, v57, v234
    v_mul_f32 v58, v58, v234
    v_mfma_f32_16x16x32_bf16 v[204:207], a[120:123], a[56:59], v[204:207]
    v_mul_f32 v59, v59, v234
    v_cvt_pk_bf16_f32 v56, v56, v57
    v_cvt_pk_bf16_f32 v57, v58, v59
    v_mfma_f32_16x16x32_bf16 v[204:207], a[124:127], a[60:63], v[204:207]
    ds_write_b64 v240, v[56:57] offset:192
    v_mul_f32 v60, v60, v234
    v_mul_f32 v61, v61, v234
    v_mul_f32 v62, v62, v234
    v_mfma_f32_16x16x32_bf16 v[200:203], a[108:111], a[60:63], v[220:223]
    v_mul_f32 v63, v63, v234
    v_cvt_pk_bf16_f32 v60, v60, v61
    v_cvt_pk_bf16_f32 v61, v62, v63
    v_mfma_f32_16x16x32_bf16 v[200:203], a[104:107], a[56:59], v[200:203]
    ds_write_b64 v240, v[60:61] offset:224
    v_mfma_f32_16x16x32_bf16 v[200:203], a[100:103], a[52:55], v[200:203]
    ds_read_b128 v[32:35], v241 offset:0
    v_mfma_f32_16x16x32_bf16 v[200:203], a[96:99], a[48:51], v[200:203]
    ds_read_b128 v[36:39], v241 offset:1088
    v_exp_f32 v207, v207
    v_exp_f32 v206, v206
    v_mfma_f32_16x16x32_bf16 v[196:199], a[80:83], a[48:51], v[220:223]
    ds_read_b128 v[40:43], v241 offset:2176
    v_exp_f32 v205, v205
    v_exp_f32 v204, v204
    v_mfma_f32_16x16x32_bf16 v[196:199], a[84:87], a[52:55], v[196:199]
    ds_read_b128 v[44:47], v241 offset:3264
    v_mfma_f32_16x16x32_bf16 v[196:199], a[88:91], a[56:59], v[196:199]
    v_mfma_f32_16x16x32_bf16 v[196:199], a[92:95], a[60:63], v[196:199]
    v_exp_f32 v203, v203
    v_exp_f32 v202, v202
    v_mfma_f32_16x16x32_bf16 v[192:195], a[76:79], a[60:63], v[220:223]
    v_exp_f32 v201, v201
    v_exp_f32 v200, v200
    v_mfma_f32_16x16x32_bf16 v[192:195], a[72:75], a[56:59], v[192:195]
    v_cvt_pk_bf16_f32 v207, v206, v207
    v_cvt_pk_bf16_f32 v206, v204, v205
    v_mfma_f32_16x16x32_bf16 v[192:195], a[68:71], a[52:55], v[192:195]
    s_waitcnt lgkmcnt(3)
    buffer_store_dwordx4 v[32:35], v242, s[20:23], s37 offen offset:0 sc1 nt
    v_mfma_f32_16x16x32_bf16 v[192:195], a[64:67], a[48:51], v[192:195]
    v_exp_f32 v199, v199
    v_exp_f32 v198, v198
    v_mfma_f32_16x16x32_bf16 v[136:139], a[192:195], v[176:179], v[136:139]
    v_exp_f32 v197, v197
    v_exp_f32 v196, v196
    v_mfma_f32_16x16x32_bf16 v[136:139], a[192:195], v[180:183], v[136:139]
    v_cvt_pk_bf16_f32 v205, v202, v203
    v_cvt_pk_bf16_f32 v204, v200, v201
    v_mfma_f32_16x16x32_bf16 v[92:95], a[188:191], v[180:183], v[92:95]
    s_waitcnt lgkmcnt(2)
    buffer_store_dwordx4 v[36:39], v242, s[20:23], s37 offen offset:1024 sc1 nt
    v_mfma_f32_16x16x32_bf16 v[92:95], a[184:187], v[176:179], v[92:95]
    v_exp_f32 v195, v195
    v_exp_f32 v194, v194
    v_mfma_f32_16x16x32_bf16 v[88:91], a[176:179], v[176:179], v[88:91]
    v_exp_f32 v193, v193
    v_exp_f32 v192, v192
    v_mfma_f32_16x16x32_bf16 v[88:91], a[180:183], v[180:183], v[88:91]
    v_cvt_pk_bf16_f32 v203, v198, v199
    v_cvt_pk_bf16_f32 v202, v196, v197
    v_cvt_pk_bf16_f32 v201, v194, v195
    v_cvt_pk_bf16_f32 v200, v192, v193
    v_mfma_f32_16x16x32_bf16 v[84:87], a[172:175], v[180:183], v[84:87]
    s_waitcnt lgkmcnt(1)
    buffer_store_dwordx4 v[40:43], v242, s[20:23], s37 offen offset:2048 sc1 nt
    v_rcp_f32 v236, v136
    v_mfma_f32_16x16x32_bf16 v[84:87], a[168:171], v[176:179], v[84:87]
    s_nop 0
    v_mul_f32 v92, v92, v236
    v_mul_f32 v93, v93, v236
    v_mul_f32 v94, v94, v236
    v_mfma_f32_16x16x32_bf16 v[80:83], a[160:163], v[176:179], v[80:83]
    v_mul_f32 v95, v95, v236
    v_cvt_pk_bf16_f32 v92, v92, v93
    v_cvt_pk_bf16_f32 v93, v94, v95
    v_mfma_f32_16x16x32_bf16 v[80:83], a[164:167], v[180:183], v[80:83]
    ds_write_b64 v240, v[92:93] offset:224
    v_mul_f32 v88, v88, v236
    v_mul_f32 v89, v89, v236
    v_mul_f32 v90, v90, v236
    v_mfma_f32_16x16x32_bf16 v[76:79], a[156:159], v[180:183], v[76:79]
    s_waitcnt lgkmcnt(1)
    buffer_store_dwordx4 v[44:47], v242, s[20:23], s37 offen offset:3072 sc1 nt
    v_mul_f32 v91, v91, v236
    v_cvt_pk_bf16_f32 v88, v88, v89
    v_mfma_f32_16x16x32_bf16 v[76:79], a[152:155], v[176:179], v[76:79]
    v_cvt_pk_bf16_f32 v89, v90, v91
    v_mul_f32 v84, v84, v236
    v_mul_f32 v85, v85, v236
    v_mul_f32 v86, v86, v236
    v_mfma_f32_16x16x32_bf16 v[72:75], a[144:147], v[176:179], v[72:75]
    ds_write_b64 v240, v[88:89] offset:192
    v_mul_f32 v87, v87, v236
    v_cvt_pk_bf16_f32 v84, v84, v85
    v_cvt_pk_bf16_f32 v85, v86, v87
    v_mfma_f32_16x16x32_bf16 v[72:75], a[148:151], v[180:183], v[72:75]
    ds_write_b64 v240, v[84:85] offset:160
    v_mul_f32 v80, v80, v236
    v_mul_f32 v81, v81, v236
    v_mul_f32 v82, v82, v236
    v_mfma_f32_16x16x32_bf16 v[68:71], a[140:143], v[180:183], v[68:71]
    v_mul_f32 v83, v83, v236
    v_cvt_pk_bf16_f32 v80, v80, v81
    v_cvt_pk_bf16_f32 v81, v82, v83
    v_mfma_f32_16x16x32_bf16 v[68:71], a[136:139], v[176:179], v[68:71]
    ds_write_b64 v240, v[80:81] offset:128
    v_mul_f32 v76, v76, v236
    v_mul_f32 v77, v77, v236
    v_mul_f32 v78, v78, v236
    v_mfma_f32_16x16x32_bf16 v[64:67], a[128:131], v[176:179], v[64:67]
    v_mul_f32 v79, v79, v236
    v_cvt_pk_bf16_f32 v76, v76, v77
    v_cvt_pk_bf16_f32 v77, v78, v79
    v_mfma_f32_16x16x32_bf16 v[64:67], a[132:135], v[180:183], v[64:67]
    ds_write_b64 v240, v[76:77] offset:96
    v_mul_f32 v72, v72, v236
    v_mul_f32 v73, v73, v236
    v_mul_f32 v74, v74, v236
    v_mfma_f32_16x16x32_bf16 v[140:143], a[192:195], v[204:207], v[140:143]
    v_mul_f32 v75, v75, v236
    v_cvt_pk_bf16_f32 v72, v72, v73
    v_cvt_pk_bf16_f32 v73, v74, v75
    v_mfma_f32_16x16x32_bf16 v[140:143], a[192:195], v[200:203], v[140:143]
    ds_write_b64 v240, v[72:73] offset:64
    v_mul_f32 v68, v68, v236
    v_mul_f32 v69, v69, v236
    v_mul_f32 v70, v70, v236
    v_mfma_f32_16x16x32_bf16 v[96:99], a[128:131], v[200:203], v[96:99]
    v_mul_f32 v71, v71, v236
    v_cvt_pk_bf16_f32 v68, v68, v69
    v_cvt_pk_bf16_f32 v69, v70, v71
    v_mfma_f32_16x16x32_bf16 v[96:99], a[132:135], v[204:207], v[96:99]
    ds_write_b64 v240, v[68:69] offset:32
    v_mul_f32 v64, v64, v236
    v_mul_f32 v65, v65, v236
    v_mul_f32 v66, v66, v236
    v_mfma_f32_16x16x32_bf16 v[100:103], a[140:143], v[204:207], v[100:103]
    v_mul_f32 v67, v67, v236
    v_cvt_pk_bf16_f32 v64, v64, v65
    v_cvt_pk_bf16_f32 v65, v66, v67
    v_mfma_f32_16x16x32_bf16 v[100:103], a[136:139], v[200:203], v[100:103]
    ds_write_b64 v240, v[64:65] offset:0
    v_rcp_f32 v238, v140
    s_nop 0
    v_mfma_f32_16x16x32_bf16 v[104:107], a[144:147], v[200:203], v[104:107]
    ds_read_b128 v[64:67], v241 offset:0
    v_mfma_f32_16x16x32_bf16 v[104:107], a[148:151], v[204:207], v[104:107]
    ds_read_b128 v[68:71], v241 offset:1088
    v_mul_f32 v96, v96, v238
    v_mul_f32 v97, v97, v238
    v_mul_f32 v98, v98, v238
    v_mfma_f32_16x16x32_bf16 v[108:111], a[156:159], v[204:207], v[108:111]
    ds_read_b128 v[72:75], v241 offset:2176
    v_mul_f32 v99, v99, v238
    v_cvt_pk_bf16_f32 v96, v96, v97
    v_cvt_pk_bf16_f32 v97, v98, v99
    v_mfma_f32_16x16x32_bf16 v[108:111], a[152:155], v[200:203], v[108:111]
    ds_read_b128 v[76:79], v241 offset:3264
    v_mul_f32 v100, v100, v238
    v_mul_f32 v101, v101, v238
    v_mul_f32 v102, v102, v238
    v_mfma_f32_16x16x32_bf16 v[112:115], a[160:163], v[200:203], v[112:115]
    ds_write_b64 v240, v[96:97] offset:0
    v_mul_f32 v103, v103, v238
    v_cvt_pk_bf16_f32 v100, v100, v101
    v_cvt_pk_bf16_f32 v101, v102, v103
    v_mfma_f32_16x16x32_bf16 v[112:115], a[164:167], v[204:207], v[112:115]
    ds_write_b64 v240, v[100:101] offset:32
    v_mul_f32 v104, v104, v238
    v_mul_f32 v105, v105, v238
    v_mul_f32 v106, v106, v238
    v_mfma_f32_16x16x32_bf16 v[116:119], a[172:175], v[204:207], v[116:119]
    v_mul_f32 v107, v107, v238
    v_cvt_pk_bf16_f32 v104, v104, v105
    v_cvt_pk_bf16_f32 v105, v106, v107
    v_mfma_f32_16x16x32_bf16 v[116:119], a[168:171], v[200:203], v[116:119]
    ds_write_b64 v240, v[104:105] offset:64
    v_mul_f32 v108, v108, v238
    v_mul_f32 v109, v109, v238
    v_mul_f32 v110, v110, v238
    v_mfma_f32_16x16x32_bf16 v[120:123], a[176:179], v[200:203], v[120:123]
    s_waitcnt lgkmcnt(6)
    buffer_store_dwordx4 v[64:67], v242, s[20:23], s38 offen offset:0 sc1 nt
    v_mul_f32 v111, v111, v238
    v_cvt_pk_bf16_f32 v108, v108, v109
    v_mfma_f32_16x16x32_bf16 v[120:123], a[180:183], v[204:207], v[120:123]
    v_cvt_pk_bf16_f32 v109, v110, v111
    v_mul_f32 v112, v112, v238
    v_mul_f32 v113, v113, v238
    v_mul_f32 v114, v114, v238
    v_mfma_f32_16x16x32_bf16 v[124:127], a[188:191], v[204:207], v[124:127]
    ds_write_b64 v240, v[108:109] offset:96
    v_mul_f32 v115, v115, v238
    v_cvt_pk_bf16_f32 v112, v112, v113
    v_cvt_pk_bf16_f32 v113, v114, v115
    v_mfma_f32_16x16x32_bf16 v[124:127], a[184:187], v[200:203], v[124:127]
    ds_write_b64 v240, v[112:113] offset:128
    v_mul_f32 v116, v116, v238
    v_mul_f32 v117, v117, v238
    v_mul_f32 v118, v118, v238
    s_nop 3
    v_mul_f32 v119, v119, v238
    v_cvt_pk_bf16_f32 v116, v116, v117
    v_cvt_pk_bf16_f32 v117, v118, v119
    s_waitcnt lgkmcnt(7)
    buffer_store_dwordx4 v[68:71], v242, s[20:23], s38 offen offset:1024 sc1 nt
    s_waitcnt lgkmcnt(6)
    buffer_store_dwordx4 v[72:75], v242, s[20:23], s38 offen offset:2048 sc1 nt
    s_waitcnt lgkmcnt(5)
    buffer_store_dwordx4 v[76:79], v242, s[20:23], s38 offen offset:3072 sc1 nt
    ds_write_b64 v240, v[116:117] offset:160
    v_mul_f32 v120, v120, v238
    v_mul_f32 v121, v121, v238
    v_mul_f32 v122, v122, v238
    v_mul_f32 v123, v123, v238
    v_cvt_pk_bf16_f32 v120, v120, v121
    v_cvt_pk_bf16_f32 v121, v122, v123
    ds_write_b64 v240, v[120:121] offset:192
    v_mul_f32 v124, v124, v238
    v_mul_f32 v125, v125, v238
    v_mul_f32 v126, v126, v238
    v_mul_f32 v127, v127, v238
    v_cvt_pk_bf16_f32 v124, v124, v125
    v_cvt_pk_bf16_f32 v125, v126, v127
    ds_write_b64 v240, v[124:125] offset:224
    ds_read_b128 v[96:99], v241 offset:0
    ds_read_b128 v[100:103], v241 offset:1088
    ds_read_b128 v[104:107], v241 offset:2176
    ds_read_b128 v[108:111], v241 offset:3264
    s_waitcnt lgkmcnt(3)
    buffer_store_dwordx4 v[96:99], v242, s[20:23], s39 offen offset:0 sc1 nt
    s_waitcnt lgkmcnt(2)
    buffer_store_dwordx4 v[100:103], v242, s[20:23], s39 offen offset:1024 sc1 nt
    s_waitcnt lgkmcnt(1)
    buffer_store_dwordx4 v[104:107], v242, s[20:23], s39 offen offset:2048 sc1 nt
    s_waitcnt lgkmcnt(0)
    buffer_store_dwordx4 v[108:111], v242, s[20:23], s39 offen offset:3072 sc1 nt
    s_mov_b32 s29, 0x5d800000
    v_cmp_ngt_f32 vcc, s29, v128
    v_cmp_ngt_f32 s[62:63], s29, v132
    s_or_b64 vcc, vcc, s[62:63]
    v_cmp_ngt_f32 s[62:63], s29, v136
    s_or_b64 vcc, vcc, s[62:63]
    v_cmp_ngt_f32 s[62:63], s29, v140
    s_or_b64 vcc, vcc, s[62:63]
    s_cmp_lg_u64 vcc, 0
    s_cselect_b32 s29, 1, 0
    s_lshl_b32 s30, s28, 2
    s_add_u32 s30, s30, 152064
    v_mov_b32 v232, s29
    v_mov_b32 v233, s30
    ds_write_b32 v233, v232
    v_mov_b32 v234, 152064
    s_waitcnt lgkmcnt(0)
    s_barrier
    ds_read_b128 v[236:239], v234
    s_waitcnt lgkmcnt(0)
    v_or3_b32 v236, v236, v237, v238
    v_or_b32 v236, v236, v239
    v_cmp_ne_u32 vcc, 0, v236
    s_cbranch_vccnz L_slow
L_end:
    s_endpgm
L_slow:
    s_waitcnt vmcnt(0) lgkmcnt(0)
    s_barrier
    v_mov_b32 v0, v248
    s_cmp_ge_u32 s2, 256
    s_cbranch_scc1 LS_end
    s_load_dwordx4 s[4:7], s[0:1], 0
    s_load_dwordx4 s[44:47], s[0:1], 16
    v_mov_b32 v248, v0
    v_lshrrev_b32 v1, 6, v0
    v_and_b32 v2, 63, v0
    v_readfirstlane_b32 s32, v1
    v_bfe_u32 v3, v2, 2, 2
    v_and_b32 v4, 3, v2
    v_lshrrev_b32 v5, 4, v2
    v_lshlrev_b32 v6, 8, v3
    v_lshl_add_u32 v6, v5, 6, v6
    v_lshl_add_u32 v6, v4, 4, v6
    v_lshl_add_u32 v6, v1, 12, v6
    v_add_u32 v228, 128, v6
    v_add_u32 v229, 96, v6
    v_add_u32 v230, 64, v6
    v_add_u32 v231, 32, v6
    v_mul_u32_u24 v6, 1056, v3
    v_lshl_add_u32 v6, v4, 6, v6
    v_lshl_add_u32 v226, v5, 4, v6
    v_mul_u32_u24 v6, 1056, v5
    v_lshl_add_u32 v6, v3, 6, v6
    v_lshl_add_u32 v6, v4, 3, v6
    v_add_u32 v227, 16896, v6
    s_mul_i32 s27, s32, 4224
    s_add_u32 s28, s27, 16896
    s_lshl_b32 s33, s2, 19
    s_lshl_b32 s34, s2, 16
    s_waitcnt lgkmcnt(0)
    s_add_u32 s8, s6, s33
    s_addc_u32 s9, s7, 0
    s_sub_u32 s8, s8, 128
    s_subb_u32 s9, s9, 0
    s_mov_b32 s10, 524416
    s_mov_b32 s11, 0x20000
    s_mov_b32 m0, s27
    s_mov_b32 s29, 0
    buffer_load_dwordx4 v228, s[8:11], s29 offen offset:0 nt lds
    buffer_load_dwordx4 v229, s[8:11], s29 offen offset:1056 nt lds
    buffer_load_dwordx4 v230, s[8:11], s29 offen offset:2112 nt lds
    buffer_load_dwordx4 v231, s[8:11], s29 offen offset:3168 nt lds
    s_add_u32 s16, s4, s34
    s_addc_u32 s17, s5, 0
    s_sub_u32 s16, s16, 128
    s_subb_u32 s17, s17, 0
    s_mov_b32 s18, 65664
    s_mov_b32 s19, 0x20000
    s_mul_i32 s24, s32, 16896
    s_add_u32 s24, s24, 84480
    s_mul_i32 s25, s32, 12288
    s_add_u32 m0, s24, 0
    s_add_u32 s26, s25, 0
    buffer_load_dwordx4 v228, s[16:19], s26 offen offset:0 nt lds
    buffer_load_dwordx4 v229, s[16:19], s26 offen offset:1056 nt lds
    buffer_load_dwordx4 v230, s[16:19], s26 offen offset:2112 nt lds
    buffer_load_dwordx4 v231, s[16:19], s26 offen offset:3168 nt lds
    s_add_u32 m0, s24, 4224
    s_add_u32 s26, s25, 4096
    buffer_load_dwordx4 v228, s[16:19], s26 offen offset:0 nt lds
    buffer_load_dwordx4 v229, s[16:19], s26 offen offset:1056 nt lds
    buffer_load_dwordx4 v230, s[16:19], s26 offen offset:2112 nt lds
    buffer_load_dwordx4 v231, s[16:19], s26 offen offset:3168 nt lds
    s_add_u32 m0, s24, 8448
    s_add_u32 s26, s25, 8192
    buffer_load_dwordx4 v228, s[16:19], s26 offen offset:0 nt lds
    buffer_load_dwordx4 v229, s[16:19], s26 offen offset:1056 nt lds
    buffer_load_dwordx4 v230, s[16:19], s26 offen offset:2112 nt lds
    buffer_load_dwordx4 v231, s[16:19], s26 offen offset:3168 nt lds
    s_add_u32 m0, s24, 12672
    s_add_u32 s26, s25, 12288
    buffer_load_dwordx4 v228, s[16:19], s26 offen offset:0 nt lds
    buffer_load_dwordx4 v229, s[16:19], s26 offen offset:1056 nt lds
    buffer_load_dwordx4 v230, s[16:19], s26 offen offset:2112 nt lds
    buffer_load_dwordx4 v231, s[16:19], s26 offen offset:3168 nt lds
    s_add_u32 s12, s44, s33
    s_addc_u32 s13, s45, 0
    s_sub_u32 s12, s12, 16512
    s_subb_u32 s13, s13, 0
    s_mov_b32 s14, 540800
    s_mov_b32 s15, 0x20000
    s_add_u32 s20, s46, s34
    s_addc_u32 s21, s47, 0
    s_mov_b32 s22, 65536
    s_mov_b32 s23, 0x20000
    s_mov_b32 s29, 16384
    s_add_u32 m0, s27, 33792
    s_nop 0
    buffer_load_dwordx4 v228, s[8:11], s29 offen offset:0 nt lds
    buffer_load_dwordx4 v229, s[8:11], s29 offen offset:1056 nt lds
    buffer_load_dwordx4 v230, s[8:11], s29 offen offset:2112 nt lds
    buffer_load_dwordx4 v231, s[8:11], s29 offen offset:3168 nt lds
    s_add_u32 m0, s28, 0
    s_nop 0
    buffer_load_dwordx4 v228, s[12:15], s29 offen offset:0 nt lds
    buffer_load_dwordx4 v229, s[12:15], s29 offen offset:1056 nt lds
    buffer_load_dwordx4 v230, s[12:15], s29 offen offset:2112 nt lds
    buffer_load_dwordx4 v231, s[12:15], s29 offen offset:3168 nt lds
    s_mov_b32 s29, 32768
    s_add_u32 m0, s27, 67584
    s_nop 0
    buffer_load_dwordx4 v228, s[8:11], s29 offen offset:0 nt lds
    buffer_load_dwordx4 v229, s[8:11], s29 offen offset:1056 nt lds
    buffer_load_dwordx4 v230, s[8:11], s29 offen offset:2112 nt lds
    buffer_load_dwordx4 v231, s[8:11], s29 offen offset:3168 nt lds
    s_add_u32 m0, s28, 33792
    s_nop 0
    buffer_load_dwordx4 v228, s[12:15], s29 offen offset:0 nt lds
    buffer_load_dwordx4 v229, s[12:15], s29 offen offset:1056 nt lds
    buffer_load_dwordx4 v230, s[12:15], s29 offen offset:2112 nt lds
    buffer_load_dwordx4 v231, s[12:15], s29 offen offset:3168 nt lds
    v_cmp_eq_u32 vcc, 0, v4
    v_mov_b32 v6, 0x3f803f80
    s_nop 0
    v_cndmask_b32 v6, 0, v6, vcc
    v_accvgpr_write_b32 a128, v6
    v_accvgpr_write_b32 a129, v6
    v_accvgpr_write_b32 a130, v6
    v_accvgpr_write_b32 a131, v6
    v_mov_b32 v0, 0
    v_mov_b32 v1, 0
    v_mov_b32 v2, 0
    v_mov_b32 v3, 0
    v_mov_b32 v4, 0
    v_mov_b32 v5, 0
    v_mov_b32 v6, 0
    v_mov_b32 v7, 0
    v_mov_b32 v8, 0
    v_mov_b32 v9, 0
    v_mov_b32 v10, 0
    v_mov_b32 v11, 0
    v_mov_b32 v12, 0
    v_mov_b32 v13, 0
    v_mov_b32 v14, 0
    v_mov_b32 v15, 0
    v_mov_b32 v16, 0
    v_mov_b32 v17, 0
    v_mov_b32 v18, 0
    v_mov_b32 v19, 0
    v_mov_b32 v20, 0
    v_mov_b32 v21, 0
    v_mov_b32 v22, 0
    v_mov_b32 v23, 0
    v_mov_b32 v24, 0
    v_mov_b32 v25, 0
    v_mov_b32 v26, 0
    v_mov_b32 v27, 0
    v_mov_b32 v28, 0
    v_mov_b32 v29, 0
    v_mov_b32 v30, 0
    v_mov_b32 v31, 0
    v_mov_b32 v32, 0
    v_mov_b32 v33, 0
    v_mov_b32 v34, 0
    v_mov_b32 v35, 0
    v_mov_b32 v36, 0
    v_mov_b32 v37, 0
    v_mov_b32 v38, 0
    v_mov_b32 v39, 0
    v_mov_b32 v40, 0
    v_mov_b32 v41, 0
    v_mov_b32 v42, 0
    v_mov_b32 v43, 0
    v_mov_b32 v44, 0
    v_mov_b32 v45, 0
    v_mov_b32 v46, 0
    v_mov_b32 v47, 0
    v_mov_b32 v48, 0
    v_mov_b32 v49, 0
    v_mov_b32 v50, 0
    v_mov_b32 v51, 0
    v_mov_b32 v52, 0
    v_mov_b32 v53, 0
    v_mov_b32 v54, 0
    v_mov_b32 v55, 0
    v_mov_b32 v56, 0
    v_mov_b32 v57, 0
    v_mov_b32 v58, 0
    v_mov_b32 v59, 0
    v_mov_b32 v60, 0
    v_mov_b32 v61, 0
    v_mov_b32 v62, 0
    v_mov_b32 v63, 0
    v_mov_b32 v64, 0
    v_mov_b32 v65, 0
    v_mov_b32 v66, 0
    v_mov_b32 v67, 0
    v_mov_b32 v68, 0
    v_mov_b32 v69, 0
    v_mov_b32 v70, 0
    v_mov_b32 v71, 0
    v_mov_b32 v72, 0
    v_mov_b32 v73, 0
    v_mov_b32 v74, 0
    v_mov_b32 v75, 0
    v_mov_b32 v76, 0
    v_mov_b32 v77, 0
    v_mov_b32 v78, 0
    v_mov_b32 v79, 0
    v_mov_b32 v80, 0
    v_mov_b32 v81, 0
    v_mov_b32 v82, 0
    v_mov_b32 v83, 0
    v_mov_b32 v84, 0
    v_mov_b32 v85, 0
    v_mov_b32 v86, 0
    v_mov_b32 v87, 0
    v_mov_b32 v88, 0
    v_mov_b32 v89, 0
    v_mov_b32 v90, 0
    v_mov_b32 v91, 0
    v_mov_b32 v92, 0
    v_mov_b32 v93, 0
    v_mov_b32 v94, 0
    v_mov_b32 v95, 0
    v_mov_b32 v96, 0
    v_mov_b32 v97, 0
    v_mov_b32 v98, 0
    v_mov_b32 v99, 0
    v_mov_b32 v100, 0
    v_mov_b32 v101, 0
    v_mov_b32 v102, 0
    v_mov_b32 v103, 0
    v_mov_b32 v104, 0
    v_mov_b32 v105, 0
    v_mov_b32 v106, 0
    v_mov_b32 v107, 0
    v_mov_b32 v108, 0
    v_mov_b32 v109, 0
    v_mov_b32 v110, 0
    v_mov_b32 v111, 0
    v_mov_b32 v112, 0
    v_mov_b32 v113, 0
    v_mov_b32 v114, 0
    v_mov_b32 v115, 0
    v_mov_b32 v116, 0
    v_mov_b32 v117, 0
    v_mov_b32 v118, 0
    v_mov_b32 v119, 0
    v_mov_b32 v120, 0
    v_mov_b32 v121, 0
    v_mov_b32 v122, 0
    v_mov_b32 v123, 0
    v_mov_b32 v124, 0
    v_mov_b32 v125, 0
    v_mov_b32 v126, 0
    v_mov_b32 v127, 0
    v_mov_b32 v128, 0
    v_mov_b32 v129, 0
    v_mov_b32 v130, 0
    v_mov_b32 v131, 0
    v_mov_b32 v132, 0
    v_mov_b32 v133, 0
    v_mov_b32 v134, 0
    v_mov_b32 v135, 0
    v_mov_b32 v136, 0
    v_mov_b32 v137, 0
    v_mov_b32 v138, 0
    v_mov_b32 v139, 0
    v_mov_b32 v140, 0
    v_mov_b32 v141, 0
    v_mov_b32 v142, 0
    v_mov_b32 v143, 0
    v_add_u32 v224, s24, v226
    s_mov_b32 s35, 0x3e0293ee
    s_mov_b32 s30, 0x00000000
    s_waitcnt vmcnt(28)
    ds_read_b128 v[144:147], v224 offset:0
    ds_read_b128 v[148:151], v224 offset:256
    ds_read_b128 v[152:155], v224 offset:512
    ds_read_b128 v[156:159], v224 offset:768
    s_waitcnt lgkmcnt(0)
    v_lshlrev_b32 v238, 16, v144
    v_and_b32 v239, 0xffff0000, v144
    v_mul_f32 v238, s35, v238
    v_mul_f32 v239, s35, v239
    v_cvt_pk_bf16_f32 v238, v238, v239
    v_accvgpr_write_b32 a0, v238
    v_lshlrev_b32 v240, 16, v145
    v_and_b32 v241, 0xffff0000, v145
    v_mul_f32 v240, s35, v240
    v_mul_f32 v241, s35, v241
    v_cvt_pk_bf16_f32 v240, v240, v241
    v_accvgpr_write_b32 a1, v240
    v_lshlrev_b32 v238, 16, v146
    v_and_b32 v239, 0xffff0000, v146
    v_mul_f32 v238, s35, v238
    v_mul_f32 v239, s35, v239
    v_cvt_pk_bf16_f32 v238, v238, v239
    v_accvgpr_write_b32 a2, v238
    v_lshlrev_b32 v240, 16, v147
    v_and_b32 v241, 0xffff0000, v147
    v_mul_f32 v240, s35, v240
    v_mul_f32 v241, s35, v241
    v_cvt_pk_bf16_f32 v240, v240, v241
    v_accvgpr_write_b32 a3, v240
    v_lshlrev_b32 v238, 16, v148
    v_and_b32 v239, 0xffff0000, v148
    v_mul_f32 v238, s35, v238
    v_mul_f32 v239, s35, v239
    v_cvt_pk_bf16_f32 v238, v238, v239
    v_accvgpr_write_b32 a4, v238
    v_lshlrev_b32 v240, 16, v149
    v_and_b32 v241, 0xffff0000, v149
    v_mul_f32 v240, s35, v240
    v_mul_f32 v241, s35, v241
    v_cvt_pk_bf16_f32 v240, v240, v241
    v_accvgpr_write_b32 a5, v240
    v_lshlrev_b32 v238, 16, v150
    v_and_b32 v239, 0xffff0000, v150
    v_mul_f32 v238, s35, v238
    v_mul_f32 v239, s35, v239
    v_cvt_pk_bf16_f32 v238, v238, v239
    v_accvgpr_write_b32 a6, v238
    v_lshlrev_b32 v240, 16, v151
    v_and_b32 v241, 0xffff0000, v151
    v_mul_f32 v240, s35, v240
    v_mul_f32 v241, s35, v241
    v_cvt_pk_bf16_f32 v240, v240, v241
    v_accvgpr_write_b32 a7, v240
    v_lshlrev_b32 v238, 16, v152
    v_and_b32 v239, 0xffff0000, v152
    v_mul_f32 v238, s35, v238
    v_mul_f32 v239, s35, v239
    v_cvt_pk_bf16_f32 v238, v238, v239
    v_accvgpr_write_b32 a8, v238
    v_lshlrev_b32 v240, 16, v153
    v_and_b32 v241, 0xffff0000, v153
    v_mul_f32 v240, s35, v240
    v_mul_f32 v241, s35, v241
    v_cvt_pk_bf16_f32 v240, v240, v241
    v_accvgpr_write_b32 a9, v240
    v_lshlrev_b32 v238, 16, v154
    v_and_b32 v239, 0xffff0000, v154
    v_mul_f32 v238, s35, v238
    v_mul_f32 v239, s35, v239
    v_cvt_pk_bf16_f32 v238, v238, v239
    v_accvgpr_write_b32 a10, v238
    v_lshlrev_b32 v240, 16, v155
    v_and_b32 v241, 0xffff0000, v155
    v_mul_f32 v240, s35, v240
    v_mul_f32 v241, s35, v241
    v_cvt_pk_bf16_f32 v240, v240, v241
    v_accvgpr_write_b32 a11, v240
    v_lshlrev_b32 v238, 16, v156
    v_and_b32 v239, 0xffff0000, v156
    v_mul_f32 v238, s35, v238
    v_mul_f32 v239, s35, v239
    v_cvt_pk_bf16_f32 v238, v238, v239
    v_accvgpr_write_b32 a12, v238
    v_lshlrev_b32 v240, 16, v157
    v_and_b32 v241, 0xffff0000, v157
    v_mul_f32 v240, s35, v240
    v_mul_f32 v241, s35, v241
    v_cvt_pk_bf16_f32 v240, v240, v241
    v_accvgpr_write_b32 a13, v240
    v_lshlrev_b32 v238, 16, v158
    v_and_b32 v239, 0xffff0000, v158
    v_mul_f32 v238, s35, v238
    v_mul_f32 v239, s35, v239
    v_cvt_pk_bf16_f32 v238, v238, v239
    v_accvgpr_write_b32 a14, v238
    v_lshlrev_b32 v240, 16, v159
    v_and_b32 v241, 0xffff0000, v159
    v_mul_f32 v240, s35, v240
    v_mul_f32 v241, s35, v241
    v_cvt_pk_bf16_f32 v240, v240, v241
    v_accvgpr_write_b32 a15, v240
    s_waitcnt vmcnt(24)
    ds_read_b128 v[160:163], v224 offset:4224
    ds_read_b128 v[164:167], v224 offset:4480
    ds_read_b128 v[168:171], v224 offset:4736
    ds_read_b128 v[172:175], v224 offset:4992
    s_waitcnt lgkmcnt(0)
    v_lshlrev_b32 v238, 16, v160
    v_and_b32 v239, 0xffff0000, v160
    v_mul_f32 v238, s35, v238
    v_mul_f32 v239, s35, v239
    v_cvt_pk_bf16_f32 v238, v238, v239
    v_accvgpr_write_b32 a16, v238
    v_lshlrev_b32 v240, 16, v161
    v_and_b32 v241, 0xffff0000, v161
    v_mul_f32 v240, s35, v240
    v_mul_f32 v241, s35, v241
    v_cvt_pk_bf16_f32 v240, v240, v241
    v_accvgpr_write_b32 a17, v240
    v_lshlrev_b32 v238, 16, v162
    v_and_b32 v239, 0xffff0000, v162
    v_mul_f32 v238, s35, v238
    v_mul_f32 v239, s35, v239
    v_cvt_pk_bf16_f32 v238, v238, v239
    v_accvgpr_write_b32 a18, v238
    v_lshlrev_b32 v240, 16, v163
    v_and_b32 v241, 0xffff0000, v163
    v_mul_f32 v240, s35, v240
    v_mul_f32 v241, s35, v241
    v_cvt_pk_bf16_f32 v240, v240, v241
    v_accvgpr_write_b32 a19, v240
    v_lshlrev_b32 v238, 16, v164
    v_and_b32 v239, 0xffff0000, v164
    v_mul_f32 v238, s35, v238
    v_mul_f32 v239, s35, v239
    v_cvt_pk_bf16_f32 v238, v238, v239
    v_accvgpr_write_b32 a20, v238
    v_lshlrev_b32 v240, 16, v165
    v_and_b32 v241, 0xffff0000, v165
    v_mul_f32 v240, s35, v240
    v_mul_f32 v241, s35, v241
    v_cvt_pk_bf16_f32 v240, v240, v241
    v_accvgpr_write_b32 a21, v240
    v_lshlrev_b32 v238, 16, v166
    v_and_b32 v239, 0xffff0000, v166
    v_mul_f32 v238, s35, v238
    v_mul_f32 v239, s35, v239
    v_cvt_pk_bf16_f32 v238, v238, v239
    v_accvgpr_write_b32 a22, v238
    v_lshlrev_b32 v240, 16, v167
    v_and_b32 v241, 0xffff0000, v167
    v_mul_f32 v240, s35, v240
    v_mul_f32 v241, s35, v241
    v_cvt_pk_bf16_f32 v240, v240, v241
    v_accvgpr_write_b32 a23, v240
    v_lshlrev_b32 v238, 16, v168
    v_and_b32 v239, 0xffff0000, v168
    v_mul_f32 v238, s35, v238
    v_mul_f32 v239, s35, v239
    v_cvt_pk_bf16_f32 v238, v238, v239
    v_accvgpr_write_b32 a24, v238
    v_lshlrev_b32 v240, 16, v169
    v_and_b32 v241, 0xffff0000, v169
    v_mul_f32 v240, s35, v240
    v_mul_f32 v241, s35, v241
    v_cvt_pk_bf16_f32 v240, v240, v241
    v_accvgpr_write_b32 a25, v240
    v_lshlrev_b32 v238, 16, v170
    v_and_b32 v239, 0xffff0000, v170
    v_mul_f32 v238, s35, v238
    v_mul_f32 v239, s35, v239
    v_cvt_pk_bf16_f32 v238, v238, v239
    v_accvgpr_write_b32 a26, v238
    v_lshlrev_b32 v240, 16, v171
    v_and_b32 v241, 0xffff0000, v171
    v_mul_f32 v240, s35, v240
    v_mul_f32 v241, s35, v241
    v_cvt_pk_bf16_f32 v240, v240, v241
    v_accvgpr_write_b32 a27, v240
    v_lshlrev_b32 v238, 16, v172
    v_and_b32 v239, 0xffff0000, v172
    v_mul_f32 v238, s35, v238
    v_mul_f32 v239, s35, v239
    v_cvt_pk_bf16_f32 v238, v238, v239
    v_accvgpr_write_b32 a28, v238
    v_lshlrev_b32 v240, 16, v173
    v_and_b32 v241, 0xffff0000, v173
    v_mul_f32 v240, s35, v240
    v_mul_f32 v241, s35, v241
    v_cvt_pk_bf16_f32 v240, v240, v241
    v_accvgpr_write_b32 a29, v240
    v_lshlrev_b32 v238, 16, v174
    v_and_b32 v239, 0xffff0000, v174
    v_mul_f32 v238, s35, v238
    v_mul_f32 v239, s35, v239
    v_cvt_pk_bf16_f32 v238, v238, v239
    v_accvgpr_write_b32 a30, v238
    v_lshlrev_b32 v240, 16, v175
    v_and_b32 v241, 0xffff0000, v175
    v_mul_f32 v240, s35, v240
    v_mul_f32 v241, s35, v241
    v_cvt_pk_bf16_f32 v240, v240, v241
    v_accvgpr_write_b32 a31, v240
    s_waitcnt vmcnt(20)
    ds_read_b128 v[176:179], v224 offset:8448
    ds_read_b128 v[180:183], v224 offset:8704
    ds_read_b128 v[184:187], v224 offset:8960
    ds_read_b128 v[188:191], v224 offset:9216
    s_waitcnt lgkmcnt(0)
    v_lshlrev_b32 v238, 16, v176
    v_and_b32 v239, 0xffff0000, v176
    v_mul_f32 v238, s35, v238
    v_mul_f32 v239, s35, v239
    v_cvt_pk_bf16_f32 v238, v238, v239
    v_accvgpr_write_b32 a32, v238
    v_lshlrev_b32 v240, 16, v177
    v_and_b32 v241, 0xffff0000, v177
    v_mul_f32 v240, s35, v240
    v_mul_f32 v241, s35, v241
    v_cvt_pk_bf16_f32 v240, v240, v241
    v_accvgpr_write_b32 a33, v240
    v_lshlrev_b32 v238, 16, v178
    v_and_b32 v239, 0xffff0000, v178
    v_mul_f32 v238, s35, v238
    v_mul_f32 v239, s35, v239
    v_cvt_pk_bf16_f32 v238, v238, v239
    v_accvgpr_write_b32 a34, v238
    v_lshlrev_b32 v240, 16, v179
    v_and_b32 v241, 0xffff0000, v179
    v_mul_f32 v240, s35, v240
    v_mul_f32 v241, s35, v241
    v_cvt_pk_bf16_f32 v240, v240, v241
    v_accvgpr_write_b32 a35, v240
    v_lshlrev_b32 v238, 16, v180
    v_and_b32 v239, 0xffff0000, v180
    v_mul_f32 v238, s35, v238
    v_mul_f32 v239, s35, v239
    v_cvt_pk_bf16_f32 v238, v238, v239
    v_accvgpr_write_b32 a36, v238
    v_lshlrev_b32 v240, 16, v181
    v_and_b32 v241, 0xffff0000, v181
    v_mul_f32 v240, s35, v240
    v_mul_f32 v241, s35, v241
    v_cvt_pk_bf16_f32 v240, v240, v241
    v_accvgpr_write_b32 a37, v240
    v_lshlrev_b32 v238, 16, v182
    v_and_b32 v239, 0xffff0000, v182
    v_mul_f32 v238, s35, v238
    v_mul_f32 v239, s35, v239
    v_cvt_pk_bf16_f32 v238, v238, v239
    v_accvgpr_write_b32 a38, v238
    v_lshlrev_b32 v240, 16, v183
    v_and_b32 v241, 0xffff0000, v183
    v_mul_f32 v240, s35, v240
    v_mul_f32 v241, s35, v241
    v_cvt_pk_bf16_f32 v240, v240, v241
    v_accvgpr_write_b32 a39, v240
    v_lshlrev_b32 v238, 16, v184
    v_and_b32 v239, 0xffff0000, v184
    v_mul_f32 v238, s35, v238
    v_mul_f32 v239, s35, v239
    v_cvt_pk_bf16_f32 v238, v238, v239
    v_accvgpr_write_b32 a40, v238
    v_lshlrev_b32 v240, 16, v185
    v_and_b32 v241, 0xffff0000, v185
    v_mul_f32 v240, s35, v240
    v_mul_f32 v241, s35, v241
    v_cvt_pk_bf16_f32 v240, v240, v241
    v_accvgpr_write_b32 a41, v240
    v_lshlrev_b32 v238, 16, v186
    v_and_b32 v239, 0xffff0000, v186
    v_mul_f32 v238, s35, v238
    v_mul_f32 v239, s35, v239
    v_cvt_pk_bf16_f32 v238, v238, v239
    v_accvgpr_write_b32 a42, v238
    v_lshlrev_b32 v240, 16, v187
    v_and_b32 v241, 0xffff0000, v187
    v_mul_f32 v240, s35, v240
    v_mul_f32 v241, s35, v241
    v_cvt_pk_bf16_f32 v240, v240, v241
    v_accvgpr_write_b32 a43, v240
    v_lshlrev_b32 v238, 16, v188
    v_and_b32 v239, 0xffff0000, v188
    v_mul_f32 v238, s35, v238
    v_mul_f32 v239, s35, v239
    v_cvt_pk_bf16_f32 v238, v238, v239
    v_accvgpr_write_b32 a44, v238
    v_lshlrev_b32 v240, 16, v189
    v_and_b32 v241, 0xffff0000, v189
    v_mul_f32 v240, s35, v240
    v_mul_f32 v241, s35, v241
    v_cvt_pk_bf16_f32 v240, v240, v241
    v_accvgpr_write_b32 a45, v240
    v_lshlrev_b32 v238, 16, v190
    v_and_b32 v239, 0xffff0000, v190
    v_mul_f32 v238, s35, v238
    v_mul_f32 v239, s35, v239
    v_cvt_pk_bf16_f32 v238, v238, v239
    v_accvgpr_write_b32 a46, v238
    v_lshlrev_b32 v240, 16, v191
    v_and_b32 v241, 0xffff0000, v191
    v_mul_f32 v240, s35, v240
    v_mul_f32 v241, s35, v241
    v_cvt_pk_bf16_f32 v240, v240, v241
    v_accvgpr_write_b32 a47, v240
    s_waitcnt vmcnt(16)
    ds_read_b128 v[192:195], v224 offset:12672
    ds_read_b128 v[196:199], v224 offset:12928
    ds_read_b128 v[200:203], v224 offset:13184
    ds_read_b128 v[204:207], v224 offset:13440
    s_waitcnt lgkmcnt(0)
    v_lshlrev_b32 v238, 16, v192
    v_and_b32 v239, 0xffff0000, v192
    v_mul_f32 v238, s35, v238
    v_mul_f32 v239, s35, v239
    v_cvt_pk_bf16_f32 v238, v238, v239
    v_accvgpr_write_b32 a48, v238
    v_lshlrev_b32 v240, 16, v193
    v_and_b32 v241, 0xffff0000, v193
    v_mul_f32 v240, s35, v240
    v_mul_f32 v241, s35, v241
    v_cvt_pk_bf16_f32 v240, v240, v241
    v_accvgpr_write_b32 a49, v240
    v_lshlrev_b32 v238, 16, v194
    v_and_b32 v239, 0xffff0000, v194
    v_mul_f32 v238, s35, v238
    v_mul_f32 v239, s35, v239
    v_cvt_pk_bf16_f32 v238, v238, v239
    v_accvgpr_write_b32 a50, v238
    v_lshlrev_b32 v240, 16, v195
    v_and_b32 v241, 0xffff0000, v195
    v_mul_f32 v240, s35, v240
    v_mul_f32 v241, s35, v241
    v_cvt_pk_bf16_f32 v240, v240, v241
    v_accvgpr_write_b32 a51, v240
    v_lshlrev_b32 v238, 16, v196
    v_and_b32 v239, 0xffff0000, v196
    v_mul_f32 v238, s35, v238
    v_mul_f32 v239, s35, v239
    v_cvt_pk_bf16_f32 v238, v238, v239
    v_accvgpr_write_b32 a52, v238
    v_lshlrev_b32 v240, 16, v197
    v_and_b32 v241, 0xffff0000, v197
    v_mul_f32 v240, s35, v240
    v_mul_f32 v241, s35, v241
    v_cvt_pk_bf16_f32 v240, v240, v241
    v_accvgpr_write_b32 a53, v240
    v_lshlrev_b32 v238, 16, v198
    v_and_b32 v239, 0xffff0000, v198
    v_mul_f32 v238, s35, v238
    v_mul_f32 v239, s35, v239
    v_cvt_pk_bf16_f32 v238, v238, v239
    v_accvgpr_write_b32 a54, v238
    v_lshlrev_b32 v240, 16, v199
    v_and_b32 v241, 0xffff0000, v199
    v_mul_f32 v240, s35, v240
    v_mul_f32 v241, s35, v241
    v_cvt_pk_bf16_f32 v240, v240, v241
    v_accvgpr_write_b32 a55, v240
    v_lshlrev_b32 v238, 16, v200
    v_and_b32 v239, 0xffff0000, v200
    v_mul_f32 v238, s35, v238
    v_mul_f32 v239, s35, v239
    v_cvt_pk_bf16_f32 v238, v238, v239
    v_accvgpr_write_b32 a56, v238
    v_lshlrev_b32 v240, 16, v201
    v_and_b32 v241, 0xffff0000, v201
    v_mul_f32 v240, s35, v240
    v_mul_f32 v241, s35, v241
    v_cvt_pk_bf16_f32 v240, v240, v241
    v_accvgpr_write_b32 a57, v240
    v_lshlrev_b32 v238, 16, v202
    v_and_b32 v239, 0xffff0000, v202
    v_mul_f32 v238, s35, v238
    v_mul_f32 v239, s35, v239
    v_cvt_pk_bf16_f32 v238, v238, v239
    v_accvgpr_write_b32 a58, v238
    v_lshlrev_b32 v240, 16, v203
    v_and_b32 v241, 0xffff0000, v203
    v_mul_f32 v240, s35, v240
    v_mul_f32 v241, s35, v241
    v_cvt_pk_bf16_f32 v240, v240, v241
    v_accvgpr_write_b32 a59, v240
    v_lshlrev_b32 v238, 16, v204
    v_and_b32 v239, 0xffff0000, v204
    v_mul_f32 v238, s35, v238
    v_mul_f32 v239, s35, v239
    v_cvt_pk_bf16_f32 v238, v238, v239
    v_accvgpr_write_b32 a60, v238
    v_lshlrev_b32 v240, 16, v205
    v_and_b32 v241, 0xffff0000, v205
    v_mul_f32 v240, s35, v240
    v_mul_f32 v241, s35, v241
    v_cvt_pk_bf16_f32 v240, v240, v241
    v_accvgpr_write_b32 a61, v240
    v_lshlrev_b32 v238, 16, v206
    v_and_b32 v239, 0xffff0000, v206
    v_mul_f32 v238, s35, v238
    v_mul_f32 v239, s35, v239
    v_cvt_pk_bf16_f32 v238, v238, v239
    v_accvgpr_write_b32 a62, v238
    v_lshlrev_b32 v240, 16, v207
    v_and_b32 v241, 0xffff0000, v207
    v_mul_f32 v240, s35, v240
    v_mul_f32 v241, s35, v241
    v_cvt_pk_bf16_f32 v240, v240, v241
    v_accvgpr_write_b32 a63, v240
    v_mov_b32 v224, v226
    s_barrier
    ds_read_b128 a[64:67], v224 offset:0
    ds_read_b128 a[68:71], v224 offset:256
    ds_read_b128 a[72:75], v224 offset:512
    ds_read_b128 a[76:79], v224 offset:768
    ds_read_b128 a[80:83], v224 offset:4224
    ds_read_b128 a[84:87], v224 offset:4480
    ds_read_b128 a[88:91], v224 offset:4736
    ds_read_b128 a[92:95], v224 offset:4992
    s_mov_b32 s29, 49152
    s_add_u32 m0, s27, 101376
    s_nop 0
    buffer_load_dwordx4 v228, s[8:11], s29 offen offset:0 nt lds
    buffer_load_dwordx4 v229, s[8:11], s29 offen offset:1056 nt lds
    buffer_load_dwordx4 v230, s[8:11], s29 offen offset:2112 nt lds
    buffer_load_dwordx4 v231, s[8:11], s29 offen offset:3168 nt lds
    s_add_u32 m0, s28, 67584
    s_nop 0
    buffer_load_dwordx4 v228, s[12:15], s29 offen offset:0 nt lds
    buffer_load_dwordx4 v229, s[12:15], s29 offen offset:1056 nt lds
    buffer_load_dwordx4 v230, s[12:15], s29 offen offset:2112 nt lds
    buffer_load_dwordx4 v231, s[12:15], s29 offen offset:3168 nt lds
    s_waitcnt lgkmcnt(0)
    v_mfma_f32_16x16x32_bf16 v[144:147], a[64:67], a[0:3], 0
    v_mfma_f32_16x16x32_bf16 v[144:147], a[68:71], a[4:7], v[144:147]
    v_mfma_f32_16x16x32_bf16 v[144:147], a[72:75], a[8:11], v[144:147]
    v_mfma_f32_16x16x32_bf16 v[144:147], a[76:79], a[12:15], v[144:147]
    v_mfma_f32_16x16x32_bf16 v[148:151], a[80:83], a[0:3], 0
    v_mfma_f32_16x16x32_bf16 v[148:151], a[84:87], a[4:7], v[148:151]
    v_mfma_f32_16x16x32_bf16 v[148:151], a[88:91], a[8:11], v[148:151]
    v_mfma_f32_16x16x32_bf16 v[148:151], a[92:95], a[12:15], v[148:151]
    v_mfma_f32_16x16x32_bf16 v[152:155], a[64:67], a[16:19], 0
    v_mfma_f32_16x16x32_bf16 v[152:155], a[68:71], a[20:23], v[152:155]
    v_mfma_f32_16x16x32_bf16 v[152:155], a[72:75], a[24:27], v[152:155]
    v_mfma_f32_16x16x32_bf16 v[152:155], a[76:79], a[28:31], v[152:155]
    v_mfma_f32_16x16x32_bf16 v[156:159], a[80:83], a[16:19], 0
    v_mfma_f32_16x16x32_bf16 v[156:159], a[84:87], a[20:23], v[156:159]
    v_mfma_f32_16x16x32_bf16 v[156:159], a[88:91], a[24:27], v[156:159]
    v_mfma_f32_16x16x32_bf16 v[156:159], a[92:95], a[28:31], v[156:159]
    v_mfma_f32_16x16x32_bf16 v[160:163], a[64:67], a[32:35], 0
    v_mfma_f32_16x16x32_bf16 v[160:163], a[68:71], a[36:39], v[160:163]
    v_mfma_f32_16x16x32_bf16 v[160:163], a[72:75], a[40:43], v[160:163]
    v_mfma_f32_16x16x32_bf16 v[160:163], a[76:79], a[44:47], v[160:163]
    v_mfma_f32_16x16x32_bf16 v[164:167], a[80:83], a[32:35], 0
    v_mfma_f32_16x16x32_bf16 v[164:167], a[84:87], a[36:39], v[164:167]
    v_mfma_f32_16x16x32_bf16 v[164:167], a[88:91], a[40:43], v[164:167]
    v_mfma_f32_16x16x32_bf16 v[164:167], a[92:95], a[44:47], v[164:167]
    v_mfma_f32_16x16x32_bf16 v[168:171], a[64:67], a[48:51], 0
    v_mfma_f32_16x16x32_bf16 v[168:171], a[68:71], a[52:55], v[168:171]
    v_mfma_f32_16x16x32_bf16 v[168:171], a[72:75], a[56:59], v[168:171]
    v_mfma_f32_16x16x32_bf16 v[168:171], a[76:79], a[60:63], v[168:171]
    v_mfma_f32_16x16x32_bf16 v[172:175], a[80:83], a[48:51], 0
    v_mfma_f32_16x16x32_bf16 v[172:175], a[84:87], a[52:55], v[172:175]
    v_mfma_f32_16x16x32_bf16 v[172:175], a[88:91], a[56:59], v[172:175]
    v_mfma_f32_16x16x32_bf16 v[172:175], a[92:95], a[60:63], v[172:175]
    ds_read_b128 a[64:67], v224 offset:8448
    ds_read_b128 a[68:71], v224 offset:8704
    ds_read_b128 a[72:75], v224 offset:8960
    ds_read_b128 a[76:79], v224 offset:9216
    ds_read_b128 a[80:83], v224 offset:12672
    ds_read_b128 a[84:87], v224 offset:12928
    ds_read_b128 a[88:91], v224 offset:13184
    ds_read_b128 a[92:95], v224 offset:13440
    v_max3_f32 v238, v144, v145, v146
    v_max3_f32 v238, v238, v147, v148
    v_max3_f32 v238, v238, v149, v150
    v_max_f32 v238, v238, v151
    v_mov_b32 v242, v238
    s_nop 1
    v_permlane16_swap_b32 v238, v242
    s_nop 1
    v_max_f32 v238, v238, v242
    v_mov_b32 v242, v238
    s_nop 1
    v_permlane32_swap_b32 v238, v242
    s_nop 1
    v_max_f32 v238, v238, v242
    v_sub_f32 v144, v144, v238
    v_sub_f32 v145, v145, v238
    v_sub_f32 v146, v146, v238
    v_sub_f32 v147, v147, v238
    v_sub_f32 v148, v148, v238
    v_sub_f32 v149, v149, v238
    v_sub_f32 v150, v150, v238
    v_sub_f32 v151, v151, v238
    v_sub_f32 v208, 0, v238
    v_sub_f32 v209, 0, v238
    v_sub_f32 v210, 0, v238
    v_sub_f32 v211, 0, v238
    v_max3_f32 v239, v152, v153, v154
    v_max3_f32 v239, v239, v155, v156
    v_max3_f32 v239, v239, v157, v158
    v_max_f32 v239, v239, v159
    v_mov_b32 v242, v239
    s_nop 1
    v_permlane16_swap_b32 v239, v242
    s_nop 1
    v_max_f32 v239, v239, v242
    v_mov_b32 v242, v239
    s_nop 1
    v_permlane32_swap_b32 v239, v242
    s_nop 1
    v_max_f32 v239, v239, v242
    v_sub_f32 v152, v152, v239
    v_sub_f32 v153, v153, v239
    v_sub_f32 v154, v154, v239
    v_sub_f32 v155, v155, v239
    v_sub_f32 v156, v156, v239
    v_sub_f32 v157, v157, v239
    v_sub_f32 v158, v158, v239
    v_sub_f32 v159, v159, v239
    v_sub_f32 v212, 0, v239
    v_sub_f32 v213, 0, v239
    v_sub_f32 v214, 0, v239
    v_sub_f32 v215, 0, v239
    v_max3_f32 v240, v160, v161, v162
    v_max3_f32 v240, v240, v163, v164
    v_max3_f32 v240, v240, v165, v166
    v_max_f32 v240, v240, v167
    v_mov_b32 v242, v240
    s_nop 1
    v_permlane16_swap_b32 v240, v242
    s_nop 1
    v_max_f32 v240, v240, v242
    v_mov_b32 v242, v240
    s_nop 1
    v_permlane32_swap_b32 v240, v242
    s_nop 1
    v_max_f32 v240, v240, v242
    v_sub_f32 v160, v160, v240
    v_sub_f32 v161, v161, v240
    v_sub_f32 v162, v162, v240
    v_sub_f32 v163, v163, v240
    v_sub_f32 v164, v164, v240
    v_sub_f32 v165, v165, v240
    v_sub_f32 v166, v166, v240
    v_sub_f32 v167, v167, v240
    v_sub_f32 v216, 0, v240
    v_sub_f32 v217, 0, v240
    v_sub_f32 v218, 0, v240
    v_sub_f32 v219, 0, v240
    v_max3_f32 v241, v168, v169, v170
    v_max3_f32 v241, v241, v171, v172
    v_max3_f32 v241, v241, v173, v174
    v_max_f32 v241, v241, v175
    v_mov_b32 v242, v241
    s_nop 1
    v_permlane16_swap_b32 v241, v242
    s_nop 1
    v_max_f32 v241, v241, v242
    v_mov_b32 v242, v241
    s_nop 1
    v_permlane32_swap_b32 v241, v242
    s_nop 1
    v_max_f32 v241, v241, v242
    v_sub_f32 v168, v168, v241
    v_sub_f32 v169, v169, v241
    v_sub_f32 v170, v170, v241
    v_sub_f32 v171, v171, v241
    v_sub_f32 v172, v172, v241
    v_sub_f32 v173, v173, v241
    v_sub_f32 v174, v174, v241
    v_sub_f32 v175, v175, v241
    v_sub_f32 v220, 0, v241
    v_sub_f32 v221, 0, v241
    v_sub_f32 v222, 0, v241
    v_sub_f32 v223, 0, v241
    s_mov_b32 s24, 101376
    s_mov_b32 s25, 0
    s_mov_b64 vcc, 0
    s_mov_b32 s26, 33792
    s_mov_b32 s29, 65536
    v_mov_b32 v225, v227
    v_exp_f32 v144, v144
    v_exp_f32 v145, v145
    v_exp_f32 v146, v146
    v_exp_f32 v147, v147
    v_exp_f32 v148, v148
    v_exp_f32 v149, v149
    v_exp_f32 v150, v150
    v_exp_f32 v151, v151
    v_exp_f32 v152, v152
    v_exp_f32 v153, v153
    v_exp_f32 v154, v154
    v_exp_f32 v155, v155
    v_exp_f32 v156, v156
    v_exp_f32 v157, v157
    v_exp_f32 v158, v158
    v_exp_f32 v159, v159
    v_exp_f32 v160, v160
    v_exp_f32 v161, v161
.p2align 6
LS_loop:
    s_waitcnt lgkmcnt(0)
    v_mfma_f32_16x16x32_bf16 v[176:179], a[64:67], a[0:3], v[208:211]
    s_waitcnt vmcnt(16)
    s_barrier
    v_mfma_f32_16x16x32_bf16 v[176:179], a[68:71], a[4:7], v[176:179]
    ds_read_b64_tr_b16 a[96:97], v225 offset:0
    v_add_u32 v224, s26, v226
    v_mfma_f32_16x16x32_bf16 v[176:179], a[72:75], a[8:11], v[176:179]
    v_exp_f32 v162, v162
    v_mfma_f32_16x16x32_bf16 v[176:179], a[76:79], a[12:15], v[176:179]
    ds_read_b64_tr_b16 a[98:99], v225 offset:4224
    v_cvt_pk_bf16_f32 v144, v144, v145
    v_mfma_f32_16x16x32_bf16 v[180:183], a[80:83], a[0:3], v[208:211]
    v_exp_f32 v163, v163
    v_mfma_f32_16x16x32_bf16 v[180:183], a[84:87], a[4:7], v[180:183]
    ds_read_b64_tr_b16 a[100:101], v225 offset:32
    v_cvt_pk_bf16_f32 v145, v146, v147
    v_mfma_f32_16x16x32_bf16 v[180:183], a[88:91], a[8:11], v[180:183]
    v_exp_f32 v164, v164
    v_mfma_f32_16x16x32_bf16 v[180:183], a[92:95], a[12:15], v[180:183]
    ds_read_b64_tr_b16 a[102:103], v225 offset:4256
    v_cvt_pk_bf16_f32 v146, v148, v149
    v_mfma_f32_16x16x32_bf16 v[184:187], a[64:67], a[16:19], v[212:215]
    v_exp_f32 v165, v165
    v_mfma_f32_16x16x32_bf16 v[184:187], a[68:71], a[20:23], v[184:187]
    ds_read_b64_tr_b16 a[104:105], v225 offset:256
    v_cvt_pk_bf16_f32 v147, v150, v151
    v_mfma_f32_16x16x32_bf16 v[184:187], a[72:75], a[24:27], v[184:187]
    v_exp_f32 v166, v166
    v_mfma_f32_16x16x32_bf16 v[184:187], a[76:79], a[28:31], v[184:187]
    ds_read_b64_tr_b16 a[106:107], v225 offset:4480
    v_cvt_pk_bf16_f32 v152, v152, v153
    v_mfma_f32_16x16x32_bf16 v[188:191], a[80:83], a[16:19], v[212:215]
    v_exp_f32 v167, v167
    v_mfma_f32_16x16x32_bf16 v[188:191], a[84:87], a[20:23], v[188:191]
    ds_read_b64_tr_b16 a[108:109], v225 offset:288
    v_cvt_pk_bf16_f32 v153, v154, v155
    v_mfma_f32_16x16x32_bf16 v[188:191], a[88:91], a[24:27], v[188:191]
    v_exp_f32 v168, v168
    v_mfma_f32_16x16x32_bf16 v[188:191], a[92:95], a[28:31], v[188:191]
    ds_read_b64_tr_b16 a[110:111], v225 offset:4512
    v_cvt_pk_bf16_f32 v154, v156, v157
    v_mfma_f32_16x16x32_bf16 v[192:195], a[64:67], a[32:35], v[216:219]
    v_exp_f32 v169, v169
    v_mfma_f32_16x16x32_bf16 v[192:195], a[68:71], a[36:39], v[192:195]
    ds_read_b64_tr_b16 a[112:113], v225 offset:512
    v_cvt_pk_bf16_f32 v155, v158, v159
    v_mfma_f32_16x16x32_bf16 v[192:195], a[72:75], a[40:43], v[192:195]
    v_exp_f32 v170, v170
    v_mfma_f32_16x16x32_bf16 v[192:195], a[76:79], a[44:47], v[192:195]
    ds_read_b64_tr_b16 a[114:115], v225 offset:4736
    v_cvt_pk_bf16_f32 v160, v160, v161
    v_mfma_f32_16x16x32_bf16 v[196:199], a[80:83], a[32:35], v[216:219]
    v_exp_f32 v171, v171
    v_mfma_f32_16x16x32_bf16 v[196:199], a[84:87], a[36:39], v[196:199]
    ds_read_b64_tr_b16 a[116:117], v225 offset:544
    v_cvt_pk_bf16_f32 v161, v162, v163
    v_mfma_f32_16x16x32_bf16 v[196:199], a[88:91], a[40:43], v[196:199]
    v_exp_f32 v172, v172
    v_mfma_f32_16x16x32_bf16 v[196:199], a[92:95], a[44:47], v[196:199]
    ds_read_b64_tr_b16 a[118:119], v225 offset:4768
    v_cvt_pk_bf16_f32 v162, v164, v165
    v_mfma_f32_16x16x32_bf16 v[200:203], a[64:67], a[48:51], v[220:223]
    v_exp_f32 v173, v173
    v_mfma_f32_16x16x32_bf16 v[200:203], a[68:71], a[52:55], v[200:203]
    ds_read_b64_tr_b16 a[120:121], v225 offset:768
    v_cvt_pk_bf16_f32 v163, v166, v167
    v_mfma_f32_16x16x32_bf16 v[200:203], a[72:75], a[56:59], v[200:203]
    ds_read_b64_tr_b16 a[122:123], v225 offset:4992
    v_cvt_pk_bf16_f32 v168, v168, v169
    v_mfma_f32_16x16x32_bf16 v[200:203], a[76:79], a[60:63], v[200:203]
    ds_read_b64_tr_b16 a[124:125], v225 offset:800
    v_cvt_pk_bf16_f32 v169, v170, v171
    v_mfma_f32_16x16x32_bf16 v[204:207], a[80:83], a[48:51], v[220:223]
    ds_read_b64_tr_b16 a[126:127], v225 offset:5024
    v_cvt_pk_bf16_f32 v170, v172, v173
    v_mfma_f32_16x16x32_bf16 v[204:207], a[84:87], a[52:55], v[204:207]
    v_exp_f32 v174, v174
    v_mfma_f32_16x16x32_bf16 v[204:207], a[88:91], a[56:59], v[204:207]
    v_exp_f32 v175, v175
    v_mfma_f32_16x16x32_bf16 v[204:207], a[92:95], a[60:63], v[204:207]
    v_cvt_pk_bf16_f32 v171, v174, v175
    s_waitcnt lgkmcnt(0)
    v_mfma_f32_16x16x32_bf16 v[0:3], a[96:99], v[144:147], v[0:3]
    ds_read_b128 a[64:67], v224 offset:0
    s_add_u32 m0, s24, s28
    v_mfma_f32_16x16x32_bf16 v[4:7], a[100:103], v[144:147], v[4:7]
    buffer_load_dwordx4 v228, s[12:15], s29 offen offset:0 nt lds
    v_mfma_f32_16x16x32_bf16 v[8:11], a[104:107], v[144:147], v[8:11]
    ds_read_b128 a[68:71], v224 offset:256
    v_mfma_f32_16x16x32_bf16 v[12:15], a[108:111], v[144:147], v[12:15]
    buffer_load_dwordx4 v229, s[12:15], s29 offen offset:1056 nt lds
    v_max3_f32 v232, v176, v177, v178
    v_mfma_f32_16x16x32_bf16 v[16:19], a[112:115], v[144:147], v[16:19]
    ds_read_b128 a[72:75], v224 offset:512
    v_max3_f32 v232, v232, v179, v180
    v_mfma_f32_16x16x32_bf16 v[20:23], a[116:119], v[144:147], v[20:23]
    buffer_load_dwordx4 v230, s[12:15], s29 offen offset:2112 nt lds
    v_max3_f32 v232, v232, v181, v182
    v_mfma_f32_16x16x32_bf16 v[24:27], a[120:123], v[144:147], v[24:27]
    ds_read_b128 a[76:79], v224 offset:768
    v_max3_f32 v232, v232, v183, v184
    v_mfma_f32_16x16x32_bf16 v[28:31], a[124:127], v[144:147], v[28:31]
    buffer_load_dwordx4 v231, s[12:15], s29 offen offset:3168 nt lds
    v_max3_f32 v232, v232, v185, v186
    v_mfma_f32_16x16x32_bf16 v[128:131], a[128:131], v[144:147], v[128:131]
    ds_read_b128 a[80:83], v224 offset:4224
    v_max3_f32 v232, v232, v187, v188
    v_mfma_f32_16x16x32_bf16 v[32:35], a[96:99], v[152:155], v[32:35]
    ds_read_b128 a[84:87], v224 offset:4480
    v_max3_f32 v232, v232, v189, v190
    v_mfma_f32_16x16x32_bf16 v[36:39], a[100:103], v[152:155], v[36:39]
    ds_read_b128 a[88:91], v224 offset:4736
    v_max3_f32 v232, v232, v191, v192
    v_mfma_f32_16x16x32_bf16 v[40:43], a[104:107], v[152:155], v[40:43]
    ds_read_b128 a[92:95], v224 offset:4992
    v_max3_f32 v233, v193, v194, v195
    v_mfma_f32_16x16x32_bf16 v[44:47], a[108:111], v[152:155], v[44:47]
    v_max3_f32 v233, v233, v196, v197
    v_max3_f32 v233, v233, v198, v199
    v_mfma_f32_16x16x32_bf16 v[48:51], a[112:115], v[152:155], v[48:51]
    v_max3_f32 v233, v233, v200, v201
    v_max3_f32 v233, v233, v202, v203
    v_mfma_f32_16x16x32_bf16 v[52:55], a[116:119], v[152:155], v[52:55]
    v_max3_f32 v233, v233, v204, v205
    v_max3_f32 v233, v233, v206, v207
    v_mfma_f32_16x16x32_bf16 v[56:59], a[120:123], v[152:155], v[56:59]
    v_max_f32 v232, v232, v233
    v_cmp_lt_f32 vcc, s30, v232
    v_mfma_f32_16x16x32_bf16 v[60:63], a[124:127], v[152:155], v[60:63]
    s_cbranch_vccnz LS_rare1_0
LS_ret1_0:
    v_mfma_f32_16x16x32_bf16 v[132:135], a[128:131], v[152:155], v[132:135]
    v_exp_f32 v176, v176
    v_mfma_f32_16x16x32_bf16 v[64:67], a[96:99], v[160:163], v[64:67]
    v_exp_f32 v177, v177
    v_mfma_f32_16x16x32_bf16 v[68:71], a[100:103], v[160:163], v[68:71]
    v_exp_f32 v178, v178
    v_mfma_f32_16x16x32_bf16 v[72:75], a[104:107], v[160:163], v[72:75]
    v_exp_f32 v179, v179
    v_mfma_f32_16x16x32_bf16 v[76:79], a[108:111], v[160:163], v[76:79]
    v_exp_f32 v180, v180
    v_mfma_f32_16x16x32_bf16 v[80:83], a[112:115], v[160:163], v[80:83]
    v_exp_f32 v181, v181
    v_mfma_f32_16x16x32_bf16 v[84:87], a[116:119], v[160:163], v[84:87]
    v_exp_f32 v182, v182
    v_mfma_f32_16x16x32_bf16 v[88:91], a[120:123], v[160:163], v[88:91]
    v_exp_f32 v183, v183
    v_mfma_f32_16x16x32_bf16 v[92:95], a[124:127], v[160:163], v[92:95]
    v_exp_f32 v184, v184
    v_mfma_f32_16x16x32_bf16 v[136:139], a[128:131], v[160:163], v[136:139]
    v_exp_f32 v185, v185
    v_mfma_f32_16x16x32_bf16 v[96:99], a[96:99], v[168:171], v[96:99]
    v_exp_f32 v186, v186
    v_mfma_f32_16x16x32_bf16 v[100:103], a[100:103], v[168:171], v[100:103]
    v_exp_f32 v187, v187
    v_mfma_f32_16x16x32_bf16 v[104:107], a[104:107], v[168:171], v[104:107]
    v_exp_f32 v188, v188
    v_mfma_f32_16x16x32_bf16 v[108:111], a[108:111], v[168:171], v[108:111]
    v_exp_f32 v189, v189
    v_mfma_f32_16x16x32_bf16 v[112:115], a[112:115], v[168:171], v[112:115]
    v_exp_f32 v190, v190
    v_mfma_f32_16x16x32_bf16 v[116:119], a[116:119], v[168:171], v[116:119]
    v_exp_f32 v191, v191
    v_mfma_f32_16x16x32_bf16 v[120:123], a[120:123], v[168:171], v[120:123]
    v_exp_f32 v192, v192
    v_mfma_f32_16x16x32_bf16 v[124:127], a[124:127], v[168:171], v[124:127]
    v_exp_f32 v193, v193
    v_mfma_f32_16x16x32_bf16 v[140:143], a[128:131], v[168:171], v[140:143]
    s_cbranch_vccnz LS_rare2_0
LS_ret2_0:
    s_waitcnt lgkmcnt(0)
    v_mfma_f32_16x16x32_bf16 v[144:147], a[64:67], a[0:3], v[208:211]
    v_exp_f32 v194, v194
    v_mfma_f32_16x16x32_bf16 v[144:147], a[68:71], a[4:7], v[144:147]
    ds_read_b64_tr_b16 a[96:97], v225 offset:8448
    v_cvt_pk_bf16_f32 v176, v176, v177
    v_mfma_f32_16x16x32_bf16 v[144:147], a[72:75], a[8:11], v[144:147]
    v_exp_f32 v195, v195
    v_mfma_f32_16x16x32_bf16 v[144:147], a[76:79], a[12:15], v[144:147]
    ds_read_b64_tr_b16 a[98:99], v225 offset:12672
    v_cvt_pk_bf16_f32 v177, v178, v179
    v_mfma_f32_16x16x32_bf16 v[148:151], a[80:83], a[0:3], v[208:211]
    v_exp_f32 v196, v196
    v_mfma_f32_16x16x32_bf16 v[148:151], a[84:87], a[4:7], v[148:151]
    ds_read_b64_tr_b16 a[100:101], v225 offset:8480
    v_cvt_pk_bf16_f32 v178, v180, v181
    v_mfma_f32_16x16x32_bf16 v[148:151], a[88:91], a[8:11], v[148:151]
    v_exp_f32 v197, v197
    v_mfma_f32_16x16x32_bf16 v[148:151], a[92:95], a[12:15], v[148:151]
    ds_read_b64_tr_b16 a[102:103], v225 offset:12704
    v_cvt_pk_bf16_f32 v179, v182, v183
    v_mfma_f32_16x16x32_bf16 v[152:155], a[64:67], a[16:19], v[212:215]
    v_exp_f32 v198, v198
    v_mfma_f32_16x16x32_bf16 v[152:155], a[68:71], a[20:23], v[152:155]
    ds_read_b64_tr_b16 a[104:105], v225 offset:8704
    v_cvt_pk_bf16_f32 v184, v184, v185
    v_mfma_f32_16x16x32_bf16 v[152:155], a[72:75], a[24:27], v[152:155]
    v_exp_f32 v199, v199
    v_mfma_f32_16x16x32_bf16 v[152:155], a[76:79], a[28:31], v[152:155]
    ds_read_b64_tr_b16 a[106:107], v225 offset:12928
    v_cvt_pk_bf16_f32 v185, v186, v187
    v_mfma_f32_16x16x32_bf16 v[156:159], a[80:83], a[16:19], v[212:215]
    v_exp_f32 v200, v200
    v_mfma_f32_16x16x32_bf16 v[156:159], a[84:87], a[20:23], v[156:159]
    ds_read_b64_tr_b16 a[108:109], v225 offset:8736
    v_cvt_pk_bf16_f32 v186, v188, v189
    v_mfma_f32_16x16x32_bf16 v[156:159], a[88:91], a[24:27], v[156:159]
    v_exp_f32 v201, v201
    v_mfma_f32_16x16x32_bf16 v[156:159], a[92:95], a[28:31], v[156:159]
    ds_read_b64_tr_b16 a[110:111], v225 offset:12960
    v_cvt_pk_bf16_f32 v187, v190, v191
    v_mfma_f32_16x16x32_bf16 v[160:163], a[64:67], a[32:35], v[216:219]
    v_exp_f32 v202, v202
    v_mfma_f32_16x16x32_bf16 v[160:163], a[68:71], a[36:39], v[160:163]
    ds_read_b64_tr_b16 a[112:113], v225 offset:8960
    v_cvt_pk_bf16_f32 v192, v192, v193
    v_mfma_f32_16x16x32_bf16 v[160:163], a[72:75], a[40:43], v[160:163]
    v_exp_f32 v203, v203
    v_mfma_f32_16x16x32_bf16 v[160:163], a[76:79], a[44:47], v[160:163]
    ds_read_b64_tr_b16 a[114:115], v225 offset:13184
    v_cvt_pk_bf16_f32 v193, v194, v195
    v_mfma_f32_16x16x32_bf16 v[164:167], a[80:83], a[32:35], v[216:219]
    v_exp_f32 v204, v204
    v_mfma_f32_16x16x32_bf16 v[164:167], a[84:87], a[36:39], v[164:167]
    ds_read_b64_tr_b16 a[116:117], v225 offset:8992
    v_cvt_pk_bf16_f32 v194, v196, v197
    v_mfma_f32_16x16x32_bf16 v[164:167], a[88:91], a[40:43], v[164:167]
    v_exp_f32 v205, v205
    v_mfma_f32_16x16x32_bf16 v[164:167], a[92:95], a[44:47], v[164:167]
    ds_read_b64_tr_b16 a[118:119], v225 offset:13216
    v_cvt_pk_bf16_f32 v195, v198, v199
    v_mfma_f32_16x16x32_bf16 v[168:171], a[64:67], a[48:51], v[220:223]
    v_exp_f32 v206, v206
    v_mfma_f32_16x16x32_bf16 v[168:171], a[68:71], a[52:55], v[168:171]
    ds_read_b64_tr_b16 a[120:121], v225 offset:9216
    v_cvt_pk_bf16_f32 v200, v200, v201
    v_mfma_f32_16x16x32_bf16 v[168:171], a[72:75], a[56:59], v[168:171]
    ds_read_b64_tr_b16 a[122:123], v225 offset:13440
    v_cvt_pk_bf16_f32 v201, v202, v203
    v_mfma_f32_16x16x32_bf16 v[168:171], a[76:79], a[60:63], v[168:171]
    ds_read_b64_tr_b16 a[124:125], v225 offset:9248
    v_cvt_pk_bf16_f32 v202, v204, v205
    v_mfma_f32_16x16x32_bf16 v[172:175], a[80:83], a[48:51], v[220:223]
    ds_read_b64_tr_b16 a[126:127], v225 offset:13472
    v_mfma_f32_16x16x32_bf16 v[172:175], a[84:87], a[52:55], v[172:175]
    s_cmp_eq_u32 s29, 573440
    s_cselect_b32 s31, 0x7f800000, s30
    v_mfma_f32_16x16x32_bf16 v[172:175], a[88:91], a[56:59], v[172:175]
    v_exp_f32 v207, v207
    v_mfma_f32_16x16x32_bf16 v[172:175], a[92:95], a[60:63], v[172:175]
    v_cvt_pk_bf16_f32 v203, v206, v207
    s_waitcnt lgkmcnt(0)
    v_mfma_f32_16x16x32_bf16 v[0:3], a[96:99], v[176:179], v[0:3]
    ds_read_b128 a[64:67], v224 offset:8448
    v_max3_f32 v232, v144, v145, v146
    s_add_u32 m0, s25, s27
    v_mfma_f32_16x16x32_bf16 v[4:7], a[100:103], v[176:179], v[4:7]
    buffer_load_dwordx4 v228, s[8:11], s29 offen offset:0 nt lds
    v_max3_f32 v232, v232, v147, v148
    v_mfma_f32_16x16x32_bf16 v[8:11], a[104:107], v[176:179], v[8:11]
    ds_read_b128 a[68:71], v224 offset:8704
    v_max3_f32 v232, v232, v149, v150
    v_max3_f32 v232, v232, v151, v152
    v_mfma_f32_16x16x32_bf16 v[12:15], a[108:111], v[176:179], v[12:15]
    buffer_load_dwordx4 v229, s[8:11], s29 offen offset:1056 nt lds
    v_max3_f32 v232, v232, v153, v154
    v_mfma_f32_16x16x32_bf16 v[16:19], a[112:115], v[176:179], v[16:19]
    ds_read_b128 a[72:75], v224 offset:8960
    v_max3_f32 v232, v232, v155, v156
    v_max3_f32 v232, v232, v157, v158
    v_mfma_f32_16x16x32_bf16 v[20:23], a[116:119], v[176:179], v[20:23]
    buffer_load_dwordx4 v230, s[8:11], s29 offen offset:2112 nt lds
    v_max3_f32 v232, v232, v159, v160
    v_mfma_f32_16x16x32_bf16 v[24:27], a[120:123], v[176:179], v[24:27]
    ds_read_b128 a[76:79], v224 offset:9216
    v_max3_f32 v233, v161, v162, v163
    v_max3_f32 v233, v233, v164, v165
    v_mfma_f32_16x16x32_bf16 v[28:31], a[124:127], v[176:179], v[28:31]
    buffer_load_dwordx4 v231, s[8:11], s29 offen offset:3168 nt lds
    v_max3_f32 v233, v233, v166, v167
    v_mfma_f32_16x16x32_bf16 v[128:131], a[128:131], v[176:179], v[128:131]
    ds_read_b128 a[80:83], v224 offset:12672
    v_max3_f32 v233, v233, v168, v169
    v_max3_f32 v233, v233, v170, v171
    v_mfma_f32_16x16x32_bf16 v[32:35], a[96:99], v[184:187], v[32:35]
    ds_read_b128 a[84:87], v224 offset:12928
    v_max3_f32 v233, v233, v172, v173
    v_mfma_f32_16x16x32_bf16 v[36:39], a[100:103], v[184:187], v[36:39]
    ds_read_b128 a[88:91], v224 offset:13184
    v_max3_f32 v233, v233, v174, v175
    v_max_f32 v232, v232, v233
    v_mfma_f32_16x16x32_bf16 v[40:43], a[104:107], v[184:187], v[40:43]
    ds_read_b128 a[92:95], v224 offset:13440
    v_cmp_lt_f32 vcc, s31, v232
    v_mfma_f32_16x16x32_bf16 v[44:47], a[108:111], v[184:187], v[44:47]
    s_cbranch_vccnz LS_rare1_1
LS_ret1_1:
    v_mfma_f32_16x16x32_bf16 v[48:51], a[112:115], v[184:187], v[48:51]
    v_exp_f32 v144, v144
    v_mfma_f32_16x16x32_bf16 v[52:55], a[116:119], v[184:187], v[52:55]
    v_exp_f32 v145, v145
    v_mfma_f32_16x16x32_bf16 v[56:59], a[120:123], v[184:187], v[56:59]
    v_exp_f32 v146, v146
    v_mfma_f32_16x16x32_bf16 v[60:63], a[124:127], v[184:187], v[60:63]
    v_exp_f32 v147, v147
    v_mfma_f32_16x16x32_bf16 v[132:135], a[128:131], v[184:187], v[132:135]
    v_exp_f32 v148, v148
    v_mfma_f32_16x16x32_bf16 v[64:67], a[96:99], v[192:195], v[64:67]
    v_exp_f32 v149, v149
    v_mfma_f32_16x16x32_bf16 v[68:71], a[100:103], v[192:195], v[68:71]
    v_exp_f32 v150, v150
    v_mfma_f32_16x16x32_bf16 v[72:75], a[104:107], v[192:195], v[72:75]
    v_exp_f32 v151, v151
    v_mfma_f32_16x16x32_bf16 v[76:79], a[108:111], v[192:195], v[76:79]
    v_exp_f32 v152, v152
    v_mfma_f32_16x16x32_bf16 v[80:83], a[112:115], v[192:195], v[80:83]
    v_exp_f32 v153, v153
    v_mfma_f32_16x16x32_bf16 v[84:87], a[116:119], v[192:195], v[84:87]
    v_exp_f32 v154, v154
    v_mfma_f32_16x16x32_bf16 v[88:91], a[120:123], v[192:195], v[88:91]
    v_exp_f32 v155, v155
    v_mfma_f32_16x16x32_bf16 v[92:95], a[124:127], v[192:195], v[92:95]
    v_exp_f32 v156, v156
    v_mfma_f32_16x16x32_bf16 v[136:139], a[128:131], v[192:195], v[136:139]
    v_exp_f32 v157, v157
    v_mfma_f32_16x16x32_bf16 v[96:99], a[96:99], v[200:203], v[96:99]
    v_exp_f32 v158, v158
    v_mfma_f32_16x16x32_bf16 v[100:103], a[100:103], v[200:203], v[100:103]
    v_exp_f32 v159, v159
    v_mfma_f32_16x16x32_bf16 v[104:107], a[104:107], v[200:203], v[104:107]
    v_exp_f32 v160, v160
    v_mfma_f32_16x16x32_bf16 v[108:111], a[108:111], v[200:203], v[108:111]
    v_exp_f32 v161, v161
    v_mfma_f32_16x16x32_bf16 v[112:115], a[112:115], v[200:203], v[112:115]
    s_mov_b32 s24, s25
    s_mov_b32 s25, s26
    v_mfma_f32_16x16x32_bf16 v[116:119], a[116:119], v[200:203], v[116:119]
    s_add_u32 s26, s26, 33792
    s_cmp_eq_u32 s26, 135168
    v_mfma_f32_16x16x32_bf16 v[120:123], a[120:123], v[200:203], v[120:123]
    s_cselect_b32 s26, 0, s26
    v_add_u32 v225, s25, v227
    v_mfma_f32_16x16x32_bf16 v[124:127], a[124:127], v[200:203], v[124:127]
    s_add_u32 s29, s29, 16384
    s_cmp_lt_u32 s29, 589824
    v_mfma_f32_16x16x32_bf16 v[140:143], a[128:131], v[200:203], v[140:143]
    s_cbranch_vccnz LS_rare2_1
LS_ret2_1:
    s_cbranch_scc1 LS_loop
    v_and_b32 v242, 15, v248
    v_lshlrev_b32 v242, 8, v242
    v_bfe_u32 v243, v248, 4, 1
    v_lshl_add_u32 v242, v243, 5, v242
    v_bfe_u32 v243, v248, 5, 1
    v_lshl_add_u32 v242, v243, 4, v242
    s_lshl_b32 s33, s32, 14
    s_nop 1
    v_rcp_f32 v238, v128
    v_rcp_f32 v239, v132
    v_rcp_f32 v240, v136
    v_rcp_f32 v241, v140
    v_mul_f32 v0, v0, v238
    v_mul_f32 v1, v1, v238
    v_mul_f32 v2, v2, v238
    v_mul_f32 v3, v3, v238
    v_mul_f32 v4, v4, v238
    v_mul_f32 v5, v5, v238
    v_mul_f32 v6, v6, v238
    v_mul_f32 v7, v7, v238
    v_mul_f32 v8, v8, v238
    v_mul_f32 v9, v9, v238
    v_mul_f32 v10, v10, v238
    v_mul_f32 v11, v11, v238
    v_mul_f32 v12, v12, v238
    v_mul_f32 v13, v13, v238
    v_mul_f32 v14, v14, v238
    v_mul_f32 v15, v15, v238
    v_cvt_pk_bf16_f32 v0, v0, v1
    v_cvt_pk_bf16_f32 v1, v2, v3
    v_cvt_pk_bf16_f32 v2, v4, v5
    v_cvt_pk_bf16_f32 v3, v6, v7
    v_cvt_pk_bf16_f32 v4, v8, v9
    v_cvt_pk_bf16_f32 v5, v10, v11
    v_cvt_pk_bf16_f32 v6, v12, v13
    v_cvt_pk_bf16_f32 v7, v14, v15
    s_nop 1
    v_permlane16_swap_b32 v0, v2
    v_permlane16_swap_b32 v1, v3
    v_permlane16_swap_b32 v4, v6
    v_permlane16_swap_b32 v5, v7
    buffer_store_dwordx4 v[0:3], v242, s[20:23], s33 offen offset:0
    buffer_store_dwordx4 v[4:7], v242, s[20:23], s33 offen offset:64
    v_mul_f32 v16, v16, v238
    v_mul_f32 v17, v17, v238
    v_mul_f32 v18, v18, v238
    v_mul_f32 v19, v19, v238
    v_mul_f32 v20, v20, v238
    v_mul_f32 v21, v21, v238
    v_mul_f32 v22, v22, v238
    v_mul_f32 v23, v23, v238
    v_mul_f32 v24, v24, v238
    v_mul_f32 v25, v25, v238
    v_mul_f32 v26, v26, v238
    v_mul_f32 v27, v27, v238
    v_mul_f32 v28, v28, v238
    v_mul_f32 v29, v29, v238
    v_mul_f32 v30, v30, v238
    v_mul_f32 v31, v31, v238
    v_cvt_pk_bf16_f32 v16, v16, v17
    v_cvt_pk_bf16_f32 v17, v18, v19
    v_cvt_pk_bf16_f32 v18, v20, v21
    v_cvt_pk_bf16_f32 v19, v22, v23
    v_cvt_pk_bf16_f32 v20, v24, v25
    v_cvt_pk_bf16_f32 v21, v26, v27
    v_cvt_pk_bf16_f32 v22, v28, v29
    v_cvt_pk_bf16_f32 v23, v30, v31
    s_nop 1
    v_permlane16_swap_b32 v16, v18
    v_permlane16_swap_b32 v17, v19
    v_permlane16_swap_b32 v20, v22
    v_permlane16_swap_b32 v21, v23
    buffer_store_dwordx4 v[16:19], v242, s[20:23], s33 offen offset:128
    buffer_store_dwordx4 v[20:23], v242, s[20:23], s33 offen offset:192
    s_add_u32 s33, s33, 4096
    v_mul_f32 v32, v32, v239
    v_mul_f32 v33, v33, v239
    v_mul_f32 v34, v34, v239
    v_mul_f32 v35, v35, v239
    v_mul_f32 v36, v36, v239
    v_mul_f32 v37, v37, v239
    v_mul_f32 v38, v38, v239
    v_mul_f32 v39, v39, v239
    v_mul_f32 v40, v40, v239
    v_mul_f32 v41, v41, v239
    v_mul_f32 v42, v42, v239
    v_mul_f32 v43, v43, v239
    v_mul_f32 v44, v44, v239
    v_mul_f32 v45, v45, v239
    v_mul_f32 v46, v46, v239
    v_mul_f32 v47, v47, v239
    v_cvt_pk_bf16_f32 v32, v32, v33
    v_cvt_pk_bf16_f32 v33, v34, v35
    v_cvt_pk_bf16_f32 v34, v36, v37
    v_cvt_pk_bf16_f32 v35, v38, v39
    v_cvt_pk_bf16_f32 v36, v40, v41
    v_cvt_pk_bf16_f32 v37, v42, v43
    v_cvt_pk_bf16_f32 v38, v44, v45
    v_cvt_pk_bf16_f32 v39, v46, v47
    s_nop 1
    v_permlane16_swap_b32 v32, v34
    v_permlane16_swap_b32 v33, v35
    v_permlane16_swap_b32 v36, v38
    v_permlane16_swap_b32 v37, v39
    buffer_store_dwordx4 v[32:35], v242, s[20:23], s33 offen offset:0
    buffer_store_dwordx4 v[36:39], v242, s[20:23], s33 offen offset:64
    v_mul_f32 v48, v48, v239
    v_mul_f32 v49, v49, v239
    v_mul_f32 v50, v50, v239
    v_mul_f32 v51, v51, v239
    v_mul_f32 v52, v52, v239
    v_mul_f32 v53, v53, v239
    v_mul_f32 v54, v54, v239
    v_mul_f32 v55, v55, v239
    v_mul_f32 v56, v56, v239
    v_mul_f32 v57, v57, v239
    v_mul_f32 v58, v58, v239
    v_mul_f32 v59, v59, v239
    v_mul_f32 v60, v60, v239
    v_mul_f32 v61, v61, v239
    v_mul_f32 v62, v62, v239
    v_mul_f32 v63, v63, v239
    v_cvt_pk_bf16_f32 v48, v48, v49
    v_cvt_pk_bf16_f32 v49, v50, v51
    v_cvt_pk_bf16_f32 v50, v52, v53
    v_cvt_pk_bf16_f32 v51, v54, v55
    v_cvt_pk_bf16_f32 v52, v56, v57
    v_cvt_pk_bf16_f32 v53, v58, v59
    v_cvt_pk_bf16_f32 v54, v60, v61
    v_cvt_pk_bf16_f32 v55, v62, v63
    s_nop 1
    v_permlane16_swap_b32 v48, v50
    v_permlane16_swap_b32 v49, v51
    v_permlane16_swap_b32 v52, v54
    v_permlane16_swap_b32 v53, v55
    buffer_store_dwordx4 v[48:51], v242, s[20:23], s33 offen offset:128
    buffer_store_dwordx4 v[52:55], v242, s[20:23], s33 offen offset:192
    s_add_u32 s33, s33, 4096
    v_mul_f32 v64, v64, v240
    v_mul_f32 v65, v65, v240
    v_mul_f32 v66, v66, v240
    v_mul_f32 v67, v67, v240
    v_mul_f32 v68, v68, v240
    v_mul_f32 v69, v69, v240
    v_mul_f32 v70, v70, v240
    v_mul_f32 v71, v71, v240
    v_mul_f32 v72, v72, v240
    v_mul_f32 v73, v73, v240
    v_mul_f32 v74, v74, v240
    v_mul_f32 v75, v75, v240
    v_mul_f32 v76, v76, v240
    v_mul_f32 v77, v77, v240
    v_mul_f32 v78, v78, v240
    v_mul_f32 v79, v79, v240
    v_cvt_pk_bf16_f32 v64, v64, v65
    v_cvt_pk_bf16_f32 v65, v66, v67
    v_cvt_pk_bf16_f32 v66, v68, v69
    v_cvt_pk_bf16_f32 v67, v70, v71
    v_cvt_pk_bf16_f32 v68, v72, v73
    v_cvt_pk_bf16_f32 v69, v74, v75
    v_cvt_pk_bf16_f32 v70, v76, v77
    v_cvt_pk_bf16_f32 v71, v78, v79
    s_nop 1
    v_permlane16_swap_b32 v64, v66
    v_permlane16_swap_b32 v65, v67
    v_permlane16_swap_b32 v68, v70
    v_permlane16_swap_b32 v69, v71
    buffer_store_dwordx4 v[64:67], v242, s[20:23], s33 offen offset:0
    buffer_store_dwordx4 v[68:71], v242, s[20:23], s33 offen offset:64
    v_mul_f32 v80, v80, v240
    v_mul_f32 v81, v81, v240
    v_mul_f32 v82, v82, v240
    v_mul_f32 v83, v83, v240
    v_mul_f32 v84, v84, v240
    v_mul_f32 v85, v85, v240
    v_mul_f32 v86, v86, v240
    v_mul_f32 v87, v87, v240
    v_mul_f32 v88, v88, v240
    v_mul_f32 v89, v89, v240
    v_mul_f32 v90, v90, v240
    v_mul_f32 v91, v91, v240
    v_mul_f32 v92, v92, v240
    v_mul_f32 v93, v93, v240
    v_mul_f32 v94, v94, v240
    v_mul_f32 v95, v95, v240
    v_cvt_pk_bf16_f32 v80, v80, v81
    v_cvt_pk_bf16_f32 v81, v82, v83
    v_cvt_pk_bf16_f32 v82, v84, v85
    v_cvt_pk_bf16_f32 v83, v86, v87
    v_cvt_pk_bf16_f32 v84, v88, v89
    v_cvt_pk_bf16_f32 v85, v90, v91
    v_cvt_pk_bf16_f32 v86, v92, v93
    v_cvt_pk_bf16_f32 v87, v94, v95
    s_nop 1
    v_permlane16_swap_b32 v80, v82
    v_permlane16_swap_b32 v81, v83
    v_permlane16_swap_b32 v84, v86
    v_permlane16_swap_b32 v85, v87
    buffer_store_dwordx4 v[80:83], v242, s[20:23], s33 offen offset:128
    buffer_store_dwordx4 v[84:87], v242, s[20:23], s33 offen offset:192
    s_add_u32 s33, s33, 4096
    v_mul_f32 v96, v96, v241
    v_mul_f32 v97, v97, v241
    v_mul_f32 v98, v98, v241
    v_mul_f32 v99, v99, v241
    v_mul_f32 v100, v100, v241
    v_mul_f32 v101, v101, v241
    v_mul_f32 v102, v102, v241
    v_mul_f32 v103, v103, v241
    v_mul_f32 v104, v104, v241
    v_mul_f32 v105, v105, v241
    v_mul_f32 v106, v106, v241
    v_mul_f32 v107, v107, v241
    v_mul_f32 v108, v108, v241
    v_mul_f32 v109, v109, v241
    v_mul_f32 v110, v110, v241
    v_mul_f32 v111, v111, v241
    v_cvt_pk_bf16_f32 v96, v96, v97
    v_cvt_pk_bf16_f32 v97, v98, v99
    v_cvt_pk_bf16_f32 v98, v100, v101
    v_cvt_pk_bf16_f32 v99, v102, v103
    v_cvt_pk_bf16_f32 v100, v104, v105
    v_cvt_pk_bf16_f32 v101, v106, v107
    v_cvt_pk_bf16_f32 v102, v108, v109
    v_cvt_pk_bf16_f32 v103, v110, v111
    s_nop 1
    v_permlane16_swap_b32 v96, v98
    v_permlane16_swap_b32 v97, v99
    v_permlane16_swap_b32 v100, v102
    v_permlane16_swap_b32 v101, v103
    buffer_store_dwordx4 v[96:99], v242, s[20:23], s33 offen offset:0
    buffer_store_dwordx4 v[100:103], v242, s[20:23], s33 offen offset:64
    v_mul_f32 v112, v112, v241
    v_mul_f32 v113, v113, v241
    v_mul_f32 v114, v114, v241
    v_mul_f32 v115, v115, v241
    v_mul_f32 v116, v116, v241
    v_mul_f32 v117, v117, v241
    v_mul_f32 v118, v118, v241
    v_mul_f32 v119, v119, v241
    v_mul_f32 v120, v120, v241
    v_mul_f32 v121, v121, v241
    v_mul_f32 v122, v122, v241
    v_mul_f32 v123, v123, v241
    v_mul_f32 v124, v124, v241
    v_mul_f32 v125, v125, v241
    v_mul_f32 v126, v126, v241
    v_mul_f32 v127, v127, v241
    v_cvt_pk_bf16_f32 v112, v112, v113
    v_cvt_pk_bf16_f32 v113, v114, v115
    v_cvt_pk_bf16_f32 v114, v116, v117
    v_cvt_pk_bf16_f32 v115, v118, v119
    v_cvt_pk_bf16_f32 v116, v120, v121
    v_cvt_pk_bf16_f32 v117, v122, v123
    v_cvt_pk_bf16_f32 v118, v124, v125
    v_cvt_pk_bf16_f32 v119, v126, v127
    s_nop 1
    v_permlane16_swap_b32 v112, v114
    v_permlane16_swap_b32 v113, v115
    v_permlane16_swap_b32 v116, v118
    v_permlane16_swap_b32 v117, v119
    buffer_store_dwordx4 v[112:115], v242, s[20:23], s33 offen offset:128
    buffer_store_dwordx4 v[116:119], v242, s[20:23], s33 offen offset:192
LS_end:
    s_endpgm
LS_rare1_0:
    v_max3_f32 v238, v176, v177, v178
    v_max3_f32 v238, v238, v179, v180
    v_max3_f32 v238, v238, v181, v182
    v_max_f32 v238, v238, v183
    v_mov_b32 v242, v238
    s_nop 1
    v_permlane16_swap_b32 v238, v242
    s_nop 1
    v_max_f32 v238, v238, v242
    v_mov_b32 v242, v238
    s_nop 1
    v_permlane32_swap_b32 v238, v242
    s_nop 1
    v_max_f32 v238, v238, v242
    v_max_f32 v238, 0, v238
    v_exp_f32 v234, -v238
    v_sub_f32 v176, v176, v238
    v_sub_f32 v177, v177, v238
    v_sub_f32 v178, v178, v238
    v_sub_f32 v179, v179, v238
    v_sub_f32 v180, v180, v238
    v_sub_f32 v181, v181, v238
    v_sub_f32 v182, v182, v238
    v_sub_f32 v183, v183, v238
    v_sub_f32 v208, v208, v238
    v_sub_f32 v209, v209, v238
    v_sub_f32 v210, v210, v238
    v_sub_f32 v211, v211, v238
    v_max3_f32 v239, v184, v185, v186
    v_max3_f32 v239, v239, v187, v188
    v_max3_f32 v239, v239, v189, v190
    v_max_f32 v239, v239, v191
    v_mov_b32 v242, v239
    s_nop 1
    v_permlane16_swap_b32 v239, v242
    s_nop 1
    v_max_f32 v239, v239, v242
    v_mov_b32 v242, v239
    s_nop 1
    v_permlane32_swap_b32 v239, v242
    s_nop 1
    v_max_f32 v239, v239, v242
    v_max_f32 v239, 0, v239
    v_exp_f32 v235, -v239
    v_sub_f32 v184, v184, v239
    v_sub_f32 v185, v185, v239
    v_sub_f32 v186, v186, v239
    v_sub_f32 v187, v187, v239
    v_sub_f32 v188, v188, v239
    v_sub_f32 v189, v189, v239
    v_sub_f32 v190, v190, v239
    v_sub_f32 v191, v191, v239
    v_sub_f32 v212, v212, v239
    v_sub_f32 v213, v213, v239
    v_sub_f32 v214, v214, v239
    v_sub_f32 v215, v215, v239
    v_max3_f32 v240, v192, v193, v194
    v_max3_f32 v240, v240, v195, v196
    v_max3_f32 v240, v240, v197, v198
    v_max_f32 v240, v240, v199
    v_mov_b32 v242, v240
    s_nop 1
    v_permlane16_swap_b32 v240, v242
    s_nop 1
    v_max_f32 v240, v240, v242
    v_mov_b32 v242, v240
    s_nop 1
    v_permlane32_swap_b32 v240, v242
    s_nop 1
    v_max_f32 v240, v240, v242
    v_max_f32 v240, 0, v240
    v_exp_f32 v236, -v240
    v_sub_f32 v192, v192, v240
    v_sub_f32 v193, v193, v240
    v_sub_f32 v194, v194, v240
    v_sub_f32 v195, v195, v240
    v_sub_f32 v196, v196, v240
    v_sub_f32 v197, v197, v240
    v_sub_f32 v198, v198, v240
    v_sub_f32 v199, v199, v240
    v_sub_f32 v216, v216, v240
    v_sub_f32 v217, v217, v240
    v_sub_f32 v218, v218, v240
    v_sub_f32 v219, v219, v240
    v_max3_f32 v241, v200, v201, v202
    v_max3_f32 v241, v241, v203, v204
    v_max3_f32 v241, v241, v205, v206
    v_max_f32 v241, v241, v207
    v_mov_b32 v242, v241
    s_nop 1
    v_permlane16_swap_b32 v241, v242
    s_nop 1
    v_max_f32 v241, v241, v242
    v_mov_b32 v242, v241
    s_nop 1
    v_permlane32_swap_b32 v241, v242
    s_nop 1
    v_max_f32 v241, v241, v242
    v_max_f32 v241, 0, v241
    v_exp_f32 v237, -v241
    v_sub_f32 v200, v200, v241
    v_sub_f32 v201, v201, v241
    v_sub_f32 v202, v202, v241
    v_sub_f32 v203, v203, v241
    v_sub_f32 v204, v204, v241
    v_sub_f32 v205, v205, v241
    v_sub_f32 v206, v206, v241
    v_sub_f32 v207, v207, v241
    v_sub_f32 v220, v220, v241
    v_sub_f32 v221, v221, v241
    v_sub_f32 v222, v222, v241
    v_sub_f32 v223, v223, v241
    s_branch LS_ret1_0
LS_rare1_1:
    v_max3_f32 v238, v144, v145, v146
    v_max3_f32 v238, v238, v147, v148
    v_max3_f32 v238, v238, v149, v150
    v_max_f32 v238, v238, v151
    v_mov_b32 v242, v238
    s_nop 1
    v_permlane16_swap_b32 v238, v242
    s_nop 1
    v_max_f32 v238, v238, v242
    v_mov_b32 v242, v238
    s_nop 1
    v_permlane32_swap_b32 v238, v242
    s_nop 1
    v_max_f32 v238, v238, v242
    v_max_f32 v238, 0, v238
    v_exp_f32 v234, -v238
    v_sub_f32 v144, v144, v238
    v_sub_f32 v145, v145, v238
    v_sub_f32 v146, v146, v238
    v_sub_f32 v147, v147, v238
    v_sub_f32 v148, v148, v238
    v_sub_f32 v149, v149, v238
    v_sub_f32 v150, v150, v238
    v_sub_f32 v151, v151, v238
    v_sub_f32 v208, v208, v238
    v_sub_f32 v209, v209, v238
    v_sub_f32 v210, v210, v238
    v_sub_f32 v211, v211, v238
    v_max3_f32 v239, v152, v153, v154
    v_max3_f32 v239, v239, v155, v156
    v_max3_f32 v239, v239, v157, v158
    v_max_f32 v239, v239, v159
    v_mov_b32 v242, v239
    s_nop 1
    v_permlane16_swap_b32 v239, v242
    s_nop 1
    v_max_f32 v239, v239, v242
    v_mov_b32 v242, v239
    s_nop 1
    v_permlane32_swap_b32 v239, v242
    s_nop 1
    v_max_f32 v239, v239, v242
    v_max_f32 v239, 0, v239
    v_exp_f32 v235, -v239
    v_sub_f32 v152, v152, v239
    v_sub_f32 v153, v153, v239
    v_sub_f32 v154, v154, v239
    v_sub_f32 v155, v155, v239
    v_sub_f32 v156, v156, v239
    v_sub_f32 v157, v157, v239
    v_sub_f32 v158, v158, v239
    v_sub_f32 v159, v159, v239
    v_sub_f32 v212, v212, v239
    v_sub_f32 v213, v213, v239
    v_sub_f32 v214, v214, v239
    v_sub_f32 v215, v215, v239
    v_max3_f32 v240, v160, v161, v162
    v_max3_f32 v240, v240, v163, v164
    v_max3_f32 v240, v240, v165, v166
    v_max_f32 v240, v240, v167
    v_mov_b32 v242, v240
    s_nop 1
    v_permlane16_swap_b32 v240, v242
    s_nop 1
    v_max_f32 v240, v240, v242
    v_mov_b32 v242, v240
    s_nop 1
    v_permlane32_swap_b32 v240, v242
    s_nop 1
    v_max_f32 v240, v240, v242
    v_max_f32 v240, 0, v240
    v_exp_f32 v236, -v240
    v_sub_f32 v160, v160, v240
    v_sub_f32 v161, v161, v240
    v_sub_f32 v162, v162, v240
    v_sub_f32 v163, v163, v240
    v_sub_f32 v164, v164, v240
    v_sub_f32 v165, v165, v240
    v_sub_f32 v166, v166, v240
    v_sub_f32 v167, v167, v240
    v_sub_f32 v216, v216, v240
    v_sub_f32 v217, v217, v240
    v_sub_f32 v218, v218, v240
    v_sub_f32 v219, v219, v240
    v_max3_f32 v241, v168, v169, v170
    v_max3_f32 v241, v241, v171, v172
    v_max3_f32 v241, v241, v173, v174
    v_max_f32 v241, v241, v175
    v_mov_b32 v242, v241
    s_nop 1
    v_permlane16_swap_b32 v241, v242
    s_nop 1
    v_max_f32 v241, v241, v242
    v_mov_b32 v242, v241
    s_nop 1
    v_permlane32_swap_b32 v241, v242
    s_nop 1
    v_max_f32 v241, v241, v242
    v_max_f32 v241, 0, v241
    v_exp_f32 v237, -v241
    v_sub_f32 v168, v168, v241
    v_sub_f32 v169, v169, v241
    v_sub_f32 v170, v170, v241
    v_sub_f32 v171, v171, v241
    v_sub_f32 v172, v172, v241
    v_sub_f32 v173, v173, v241
    v_sub_f32 v174, v174, v241
    v_sub_f32 v175, v175, v241
    v_sub_f32 v220, v220, v241
    v_sub_f32 v221, v221, v241
    v_sub_f32 v222, v222, v241
    v_sub_f32 v223, v223, v241
    s_branch LS_ret1_1
LS_rare2_0:
    s_nop 15
    v_mul_f32 v0, v0, v234
    v_mul_f32 v1, v1, v234
    v_mul_f32 v2, v2, v234
    v_mul_f32 v3, v3, v234
    v_mul_f32 v4, v4, v234
    v_mul_f32 v5, v5, v234
    v_mul_f32 v6, v6, v234
    v_mul_f32 v7, v7, v234
    v_mul_f32 v8, v8, v234
    v_mul_f32 v9, v9, v234
    v_mul_f32 v10, v10, v234
    v_mul_f32 v11, v11, v234
    v_mul_f32 v12, v12, v234
    v_mul_f32 v13, v13, v234
    v_mul_f32 v14, v14, v234
    v_mul_f32 v15, v15, v234
    v_mul_f32 v16, v16, v234
    v_mul_f32 v17, v17, v234
    v_mul_f32 v18, v18, v234
    v_mul_f32 v19, v19, v234
    v_mul_f32 v20, v20, v234
    v_mul_f32 v21, v21, v234
    v_mul_f32 v22, v22, v234
    v_mul_f32 v23, v23, v234
    v_mul_f32 v24, v24, v234
    v_mul_f32 v25, v25, v234
    v_mul_f32 v26, v26, v234
    v_mul_f32 v27, v27, v234
    v_mul_f32 v28, v28, v234
    v_mul_f32 v29, v29, v234
    v_mul_f32 v30, v30, v234
    v_mul_f32 v31, v31, v234
    v_mul_f32 v128, v128, v234
    v_mul_f32 v32, v32, v235
    v_mul_f32 v33, v33, v235
    v_mul_f32 v34, v34, v235
    v_mul_f32 v35, v35, v235
    v_mul_f32 v36, v36, v235
    v_mul_f32 v37, v37, v235
    v_mul_f32 v38, v38, v235
    v_mul_f32 v39, v39, v235
    v_mul_f32 v40, v40, v235
    v_mul_f32 v41, v41, v235
    v_mul_f32 v42, v42, v235
    v_mul_f32 v43, v43, v235
    v_mul_f32 v44, v44, v235
    v_mul_f32 v45, v45, v235
    v_mul_f32 v46, v46, v235
    v_mul_f32 v47, v47, v235
    v_mul_f32 v48, v48, v235
    v_mul_f32 v49, v49, v235
    v_mul_f32 v50, v50, v235
    v_mul_f32 v51, v51, v235
    v_mul_f32 v52, v52, v235
    v_mul_f32 v53, v53, v235
    v_mul_f32 v54, v54, v235
    v_mul_f32 v55, v55, v235
    v_mul_f32 v56, v56, v235
    v_mul_f32 v57, v57, v235
    v_mul_f32 v58, v58, v235
    v_mul_f32 v59, v59, v235
    v_mul_f32 v60, v60, v235
    v_mul_f32 v61, v61, v235
    v_mul_f32 v62, v62, v235
    v_mul_f32 v63, v63, v235
    v_mul_f32 v132, v132, v235
    v_mul_f32 v64, v64, v236
    v_mul_f32 v65, v65, v236
    v_mul_f32 v66, v66, v236
    v_mul_f32 v67, v67, v236
    v_mul_f32 v68, v68, v236
    v_mul_f32 v69, v69, v236
    v_mul_f32 v70, v70, v236
    v_mul_f32 v71, v71, v236
    v_mul_f32 v72, v72, v236
    v_mul_f32 v73, v73, v236
    v_mul_f32 v74, v74, v236
    v_mul_f32 v75, v75, v236
    v_mul_f32 v76, v76, v236
    v_mul_f32 v77, v77, v236
    v_mul_f32 v78, v78, v236
    v_mul_f32 v79, v79, v236
    v_mul_f32 v80, v80, v236
    v_mul_f32 v81, v81, v236
    v_mul_f32 v82, v82, v236
    v_mul_f32 v83, v83, v236
    v_mul_f32 v84, v84, v236
    v_mul_f32 v85, v85, v236
    v_mul_f32 v86, v86, v236
    v_mul_f32 v87, v87, v236
    v_mul_f32 v88, v88, v236
    v_mul_f32 v89, v89, v236
    v_mul_f32 v90, v90, v236
    v_mul_f32 v91, v91, v236
    v_mul_f32 v92, v92, v236
    v_mul_f32 v93, v93, v236
    v_mul_f32 v94, v94, v236
    v_mul_f32 v95, v95, v236
    v_mul_f32 v136, v136, v236
    v_mul_f32 v96, v96, v237
    v_mul_f32 v97, v97, v237
    v_mul_f32 v98, v98, v237
    v_mul_f32 v99, v99, v237
    v_mul_f32 v100, v100, v237
    v_mul_f32 v101, v101, v237
    v_mul_f32 v102, v102, v237
    v_mul_f32 v103, v103, v237
    v_mul_f32 v104, v104, v237
    v_mul_f32 v105, v105, v237
    v_mul_f32 v106, v106, v237
    v_mul_f32 v107, v107, v237
    v_mul_f32 v108, v108, v237
    v_mul_f32 v109, v109, v237
    v_mul_f32 v110, v110, v237
    v_mul_f32 v111, v111, v237
    v_mul_f32 v112, v112, v237
    v_mul_f32 v113, v113, v237
    v_mul_f32 v114, v114, v237
    v_mul_f32 v115, v115, v237
    v_mul_f32 v116, v116, v237
    v_mul_f32 v117, v117, v237
    v_mul_f32 v118, v118, v237
    v_mul_f32 v119, v119, v237
    v_mul_f32 v120, v120, v237
    v_mul_f32 v121, v121, v237
    v_mul_f32 v122, v122, v237
    v_mul_f32 v123, v123, v237
    v_mul_f32 v124, v124, v237
    v_mul_f32 v125, v125, v237
    v_mul_f32 v126, v126, v237
    v_mul_f32 v127, v127, v237
    v_mul_f32 v140, v140, v237
    s_nop 1
    s_branch LS_ret2_0
LS_rare2_1:
    s_nop 15
    v_mul_f32 v0, v0, v234
    v_mul_f32 v1, v1, v234
    v_mul_f32 v2, v2, v234
    v_mul_f32 v3, v3, v234
    v_mul_f32 v4, v4, v234
    v_mul_f32 v5, v5, v234
    v_mul_f32 v6, v6, v234
    v_mul_f32 v7, v7, v234
    v_mul_f32 v8, v8, v234
    v_mul_f32 v9, v9, v234
    v_mul_f32 v10, v10, v234
    v_mul_f32 v11, v11, v234
    v_mul_f32 v12, v12, v234
    v_mul_f32 v13, v13, v234
    v_mul_f32 v14, v14, v234
    v_mul_f32 v15, v15, v234
    v_mul_f32 v16, v16, v234
    v_mul_f32 v17, v17, v234
    v_mul_f32 v18, v18, v234
    v_mul_f32 v19, v19, v234
    v_mul_f32 v20, v20, v234
    v_mul_f32 v21, v21, v234
    v_mul_f32 v22, v22, v234
    v_mul_f32 v23, v23, v234
    v_mul_f32 v24, v24, v234
    v_mul_f32 v25, v25, v234
    v_mul_f32 v26, v26, v234
    v_mul_f32 v27, v27, v234
    v_mul_f32 v28, v28, v234
    v_mul_f32 v29, v29, v234
    v_mul_f32 v30, v30, v234
    v_mul_f32 v31, v31, v234
    v_mul_f32 v128, v128, v234
    v_mul_f32 v32, v32, v235
    v_mul_f32 v33, v33, v235
    v_mul_f32 v34, v34, v235
    v_mul_f32 v35, v35, v235
    v_mul_f32 v36, v36, v235
    v_mul_f32 v37, v37, v235
    v_mul_f32 v38, v38, v235
    v_mul_f32 v39, v39, v235
    v_mul_f32 v40, v40, v235
    v_mul_f32 v41, v41, v235
    v_mul_f32 v42, v42, v235
    v_mul_f32 v43, v43, v235
    v_mul_f32 v44, v44, v235
    v_mul_f32 v45, v45, v235
    v_mul_f32 v46, v46, v235
    v_mul_f32 v47, v47, v235
    v_mul_f32 v48, v48, v235
    v_mul_f32 v49, v49, v235
    v_mul_f32 v50, v50, v235
    v_mul_f32 v51, v51, v235
    v_mul_f32 v52, v52, v235
    v_mul_f32 v53, v53, v235
    v_mul_f32 v54, v54, v235
    v_mul_f32 v55, v55, v235
    v_mul_f32 v56, v56, v235
    v_mul_f32 v57, v57, v235
    v_mul_f32 v58, v58, v235
    v_mul_f32 v59, v59, v235
    v_mul_f32 v60, v60, v235
    v_mul_f32 v61, v61, v235
    v_mul_f32 v62, v62, v235
    v_mul_f32 v63, v63, v235
    v_mul_f32 v132, v132, v235
    v_mul_f32 v64, v64, v236
    v_mul_f32 v65, v65, v236
    v_mul_f32 v66, v66, v236
    v_mul_f32 v67, v67, v236
    v_mul_f32 v68, v68, v236
    v_mul_f32 v69, v69, v236
    v_mul_f32 v70, v70, v236
    v_mul_f32 v71, v71, v236
    v_mul_f32 v72, v72, v236
    v_mul_f32 v73, v73, v236
    v_mul_f32 v74, v74, v236
    v_mul_f32 v75, v75, v236
    v_mul_f32 v76, v76, v236
    v_mul_f32 v77, v77, v236
    v_mul_f32 v78, v78, v236
    v_mul_f32 v79, v79, v236
    v_mul_f32 v80, v80, v236
    v_mul_f32 v81, v81, v236
    v_mul_f32 v82, v82, v236
    v_mul_f32 v83, v83, v236
    v_mul_f32 v84, v84, v236
    v_mul_f32 v85, v85, v236
    v_mul_f32 v86, v86, v236
    v_mul_f32 v87, v87, v236
    v_mul_f32 v88, v88, v236
    v_mul_f32 v89, v89, v236
    v_mul_f32 v90, v90, v236
    v_mul_f32 v91, v91, v236
    v_mul_f32 v92, v92, v236
    v_mul_f32 v93, v93, v236
    v_mul_f32 v94, v94, v236
    v_mul_f32 v95, v95, v236
    v_mul_f32 v136, v136, v236
    v_mul_f32 v96, v96, v237
    v_mul_f32 v97, v97, v237
    v_mul_f32 v98, v98, v237
    v_mul_f32 v99, v99, v237
    v_mul_f32 v100, v100, v237
    v_mul_f32 v101, v101, v237
    v_mul_f32 v102, v102, v237
    v_mul_f32 v103, v103, v237
    v_mul_f32 v104, v104, v237
    v_mul_f32 v105, v105, v237
    v_mul_f32 v106, v106, v237
    v_mul_f32 v107, v107, v237
    v_mul_f32 v108, v108, v237
    v_mul_f32 v109, v109, v237
    v_mul_f32 v110, v110, v237
    v_mul_f32 v111, v111, v237
    v_mul_f32 v112, v112, v237
    v_mul_f32 v113, v113, v237
    v_mul_f32 v114, v114, v237
    v_mul_f32 v115, v115, v237
    v_mul_f32 v116, v116, v237
    v_mul_f32 v117, v117, v237
    v_mul_f32 v118, v118, v237
    v_mul_f32 v119, v119, v237
    v_mul_f32 v120, v120, v237
    v_mul_f32 v121, v121, v237
    v_mul_f32 v122, v122, v237
    v_mul_f32 v123, v123, v237
    v_mul_f32 v124, v124, v237
    v_mul_f32 v125, v125, v237
    v_mul_f32 v126, v126, v237
    v_mul_f32 v127, v127, v237
    v_mul_f32 v140, v140, v237
    s_nop 1
    s_branch LS_ret2_1
.section .rodata,"a"
.p2align 6
.amdhsa_kernel standalone__gqa_softmax__near_ridge_kernel
  .amdhsa_next_free_vgpr 452
  .amdhsa_next_free_sgpr 102
  .amdhsa_accum_offset 256
  .amdhsa_group_segment_fixed_size 0
  .amdhsa_kernarg_size 48
  .amdhsa_user_sgpr_count 2
  .amdhsa_user_sgpr_kernarg_segment_ptr 1
  .amdhsa_system_sgpr_workgroup_id_x 1
.end_amdhsa_kernel
```
